```python
import torch

def _softmax(x, axis=-1):
    return torch.softmax(x, dim=axis)
def _gelu(x):
    return torch.nn.functional.gelu(x, approximate="tanh")
def _silu(x):
    return torch.nn.functional.silu(x)
def _sigmoid(x):
    return torch.sigmoid(x)
def _layernorm(x, axis=-1, eps=1e-5):
    m = x.mean(dim=axis, keepdim=True)
    v = x.var(dim=axis, keepdim=True, unbiased=False)
    return (x - m) / torch.sqrt(v + eps)
def _scatter_add(tgt, idx, src, axis=0):
    return tgt.clone().index_add_(axis, idx, src)
def _segment_sum(src, seg, n):
    out = torch.zeros((n,) + src.shape[1:], dtype=src.dtype)
    return out.index_add_(0, seg, src)
def _pad(x, pw):
    flat = tuple(v for pair in reversed(pw) for v in pair)
    return torch.nn.functional.pad(x, flat)

kernel_name = 'sequential_preLN__mha_block__moe_arch_mod__prompt'

def setup_inputs():

    _w = (lambda a: (lambda t: t.to(torch.bfloat16) if t.is_floating_point() else t)(torch.as_tensor(a)))
    def _A_setup():
        B, S, D, H = 1, 2048, 576, 32
        return {
            "x": _w((lambda *s: torch.randn(*s, dtype=torch.bfloat16) * 0.05)(B, S, D)),
            "wqkv": _w((lambda *s: torch.randn(*s, dtype=torch.bfloat16) * 0.05)(D, 3 * D)),
            "wo": _w((lambda *s: torch.randn(*s, dtype=torch.bfloat16) * 0.05)(D, D)),
        }
    _A_in = _A_setup()

    def _B_setup():
        B, S, D, F, C = 1, 2048, 576, 4608, 1
        return {
            "x": _w((lambda *s: torch.randn(*s, dtype=torch.bfloat16) * 0.05)(B, S, D)),
            "w_r": _w((lambda *s: torch.randn(*s, dtype=torch.bfloat16) * 0.05)(D)),
            "w_gate": _w((lambda *s: torch.randn(*s, dtype=torch.bfloat16) * 0.05)(D, F)),
            "w_up": _w((lambda *s: torch.randn(*s, dtype=torch.bfloat16) * 0.05)(D, F)),
            "w_down": _w((lambda *s: torch.randn(*s, dtype=torch.bfloat16) * 0.05)(F, D)),
        }
    _B_in = _B_setup()

    return {
        "A_x": _A_in["x"],
        "A_wqkv": _A_in["wqkv"],
        "A_wo": _A_in["wo"],
        "B_x": _B_in["x"],
        "B_w_r": _B_in["w_r"],
        "B_w_gate": _B_in["w_gate"],
        "B_w_up": _B_in["w_up"],
        "B_w_down": _B_in["w_down"],
    }

def reference(A_x, A_wqkv, A_wo, B_x, B_w_r, B_w_gate, B_w_up, B_w_down):
    def _A_ref(x, wqkv, wo):
        B, S, D = x.shape
        H = 32
        Dh = D // H
        qkv = (lambda x, *d: x.permute(*d))((x @ wqkv).reshape(B, S, 3, H, Dh), 2, 0, 3, 1, 4)
        q, k, v = qkv[0], qkv[1], qkv[2]
        scores = torch.einsum("bhqd,bhkd->bhqk", q, k) * (Dh ** -0.5)
        p = _softmax(scores, axis=-1)
        o = torch.einsum("bhqk,bhkd->bhqd", p, v)
        return (lambda x, *d: x.permute(*d))(o, 0, 2, 1, 3).reshape(B, S, D) @ wo

    def _B_ref(x, w_r, w_gate, w_up, w_down):
        B, S, D = x.shape
        C = 1
        r = x @ w_r
        idx = torch.argsort(-r, axis=-1)[:, :C]
        idx_e = (lambda x, n, axis: torch.repeat_interleave(x, n, dim=axis))(idx.reshape(B, C, 1), D, axis=2)
        x_sel = (lambda x, i, axis: torch.take_along_dim(x, i, dim=axis))(x, idx_e, axis=1)
        g = _silu(x_sel @ w_gate)
        u = x_sel @ w_up
        y = (g * u) @ w_down
        r_sel = _sigmoid((lambda x, i, axis: torch.take_along_dim(x, i, dim=axis))(r, idx, axis=1))
        y = y * r_sel.reshape(B, C, 1)
        b_off = (torch.arange(B) * S).reshape(B, 1)
        flat_idx = (idx + b_off).reshape(B * C)
        zero = (x * 0.0).reshape(B * S, D)
        upd = _scatter_add(zero, flat_idx, y.reshape(B * C, D), axis=0)
        return x + upd.reshape(B, S, D)

    x = A_x
    h = x + _A_ref(_layernorm(x, axis=-1), A_wqkv, A_wo)
    h2 = h + _B_ref(_layernorm(h, axis=-1), B_w_r, B_w_gate, B_w_up, B_w_down)
    return h2
```

```asm
; @launch kernel=k1_qkv_kernel grid=(256,1,1) block=(512,1,1) lds=135168
; @launch kernel=k2_attn_kernel grid=(256,1,1) block=(768,1,1) lds=161856
.amdgcn_target "amdgcn-amd-amdhsa--gfx950"
.text
.p2align 8
.globl k1_qkv_kernel
.type k1_qkv_kernel,@function
k1_qkv_kernel:
    s_cmp_ge_u32 s2, 256
    s_cbranch_scc1 k1_qkv_kernel_end
    s_load_dwordx4 s[4:7], s[0:1], 0
    s_load_dwordx2 s[8:9], s[0:1], 80
    s_load_dwordx2 s[74:75], s[0:1], 72
    s_and_b32 s10, s2, 7
    s_lshr_b32 s11, s2, 3
    s_getpc_b64 s[76:77]
k1_qkv_kernel_pc:
    s_sub_u32 s76, s76, k1_qkv_kernel_pc-k1_qkv_kernel
    s_subb_u32 s77, s77, 0
    v_lshl_add_u32 v15, s11, 4, v0
    v_min_u32 v15, (code_end_marker-k1_qkv_kernel)/64, v15
    v_lshlrev_b32 v15, 6, v15
    v_cmp_gt_u32 vcc, 16, v0
    s_nop 0
    s_and_saveexec_b64 s[78:79], vcc
    s_cbranch_execz k1_qkv_kernel_npc
    global_load_dword v15, v15, s[76:77]
k1_qkv_kernel_npc:
    s_mov_b64 exec, -1
    s_and_b32 s24, s10, 3
    s_lshl_b32 s24, s24, 2
    s_and_b32 s30, s11, 3
    s_add_u32 s24, s24, s30
    s_lshr_b32 s25, s10, 2
    s_lshl_b32 s25, s25, 3
    s_lshr_b32 s30, s11, 2
    s_add_u32 s25, s25, s30
    v_and_b32 v1, 63, v0
    v_lshrrev_b32 v16, 6, v0
    v_and_b32 v2, 31, v0
    v_readfirstlane_b32 s26, v16
    v_bfe_u32 v3, v0, 5, 1
    s_mul_i32 s28, s25, 147456
    s_mul_i32 s29, s24, 216
    s_cmp_lt_u32 s26, 4
    s_cbranch_scc1 k1_qkv_kernel_comp
k1_qkv_kernel_splice:
k1_qkv_kernel_loader:
    s_and_b32 s44, s26, 1
    s_bfe_u32 s45, s26, 0x10001
    v_lshrrev_b32 v16, 3, v1
    s_lshl_b32 s30, s44, 3
    v_add_u32 v16, s30, v16
    v_mul_u32_u24 v4, 1152, v16
    s_lshl_b32 s30, s44, 2
    v_lshrrev_b32 v16, 4, v1
    v_add_u32 v17, s30, v16
    v_and_b32 v18, 7, v1
    v_xor_b32 v18, v18, v17
    v_lshl_add_u32 v4, v18, 4, v4
    v_mul_u32_u24 v5, 3456, v17
    v_and_b32 v18, 15, v1
    v_lshlrev_b32 v19, 2, v16
    v_xor_b32 v18, v18, v19
    v_lshl_add_u32 v5, v18, 4, v5
    v_cmp_gt_u32 s[32:33], 14, v18
    s_cmp_eq_u32 s45, 1
    s_cselect_b64 s[34:35], -1, 0
    v_cndmask_b32 v4, v4, v5, s[34:35]
    s_cselect_b32 s48, s29, s28
    s_mov_b32 s46, 18432
    s_cselect_b32 s46, 27648, s46
    s_mov_b32 s47, 128
    s_cselect_b32 s47, 221184, s47
    s_lshl_b32 s37, s45, 14
    s_lshl_b32 s30, s44, 10
    s_add_u32 s37, s37, s30
    s_cmp_eq_u32 s45, 1
    s_mov_b32 s14, 2359296
    s_cselect_b32 s14, 1990656, s14
    s_mov_b32 s15, 0x00020000
    s_cselect_b64 s[32:33], s[32:33], -1
    s_waitcnt lgkmcnt(0)
    s_cselect_b32 s12, s6, s4
    s_cselect_b32 s13, s7, s5
    s_mov_b64 exec, s[32:33]
    s_mov_b32 s50, s48
    s_add_u32 s49, s24, s25
    s_mul_i32 s30, s49, 57
    s_lshr_b32 s30, s30, 9
    s_mul_i32 s30, s30, 9
    s_sub_u32 s49, s49, s30
    s_mul_i32 s30, s49, s47
    s_add_u32 s48, s48, s30
    s_mov_b32 s36, 0
    s_mov_b32 s30, s48
    s_add_u32 m0, s37, 0
    s_nop 0
    buffer_load_dwordx4 v4, s[12:15], s30 offen lds
    s_add_u32 s30, s30, s46
    s_add_u32 m0, s37, 2048
    s_nop 0
    buffer_load_dwordx4 v4, s[12:15], s30 offen lds
    s_add_u32 s30, s30, s46
    s_add_u32 m0, s37, 4096
    s_nop 0
    buffer_load_dwordx4 v4, s[12:15], s30 offen lds
    s_add_u32 s30, s30, s46
    s_add_u32 m0, s37, 6144
    s_nop 0
    buffer_load_dwordx4 v4, s[12:15], s30 offen lds
    s_add_u32 s30, s30, s46
    s_add_u32 m0, s37, 8192
    s_nop 0
    buffer_load_dwordx4 v4, s[12:15], s30 offen lds
    s_add_u32 s30, s30, s46
    s_add_u32 m0, s37, 10240
    s_nop 0
    buffer_load_dwordx4 v4, s[12:15], s30 offen lds
    s_add_u32 s30, s30, s46
    s_add_u32 m0, s37, 12288
    s_nop 0
    buffer_load_dwordx4 v4, s[12:15], s30 offen lds
    s_add_u32 s30, s30, s46
    s_add_u32 m0, s37, 14336
    s_nop 0
    buffer_load_dwordx4 v4, s[12:15], s30 offen lds
    s_add_u32 s30, s30, s46
    s_add_u32 s48, s48, s47
    s_add_u32 s49, s49, 1
    s_cmp_eq_u32 s49, 9
    s_cselect_b32 s48, s50, s48
    s_add_u32 s37, s37, 32768
    s_and_b32 s37, s37, 0x1ffff
    s_mov_b32 s30, s48
    s_add_u32 m0, s37, 0
    s_nop 0
    buffer_load_dwordx4 v4, s[12:15], s30 offen lds
    s_add_u32 s30, s30, s46
    s_add_u32 m0, s37, 2048
    s_nop 0
    buffer_load_dwordx4 v4, s[12:15], s30 offen lds
    s_add_u32 s30, s30, s46
    s_add_u32 m0, s37, 4096
    s_nop 0
    buffer_load_dwordx4 v4, s[12:15], s30 offen lds
    s_add_u32 s30, s30, s46
    s_add_u32 m0, s37, 6144
    s_nop 0
    buffer_load_dwordx4 v4, s[12:15], s30 offen lds
    s_add_u32 s30, s30, s46
    s_add_u32 m0, s37, 8192
    s_nop 0
    buffer_load_dwordx4 v4, s[12:15], s30 offen lds
    s_add_u32 s30, s30, s46
    s_add_u32 m0, s37, 10240
    s_nop 0
    buffer_load_dwordx4 v4, s[12:15], s30 offen lds
    s_add_u32 s30, s30, s46
    s_add_u32 m0, s37, 12288
    s_nop 0
    buffer_load_dwordx4 v4, s[12:15], s30 offen lds
    s_add_u32 s30, s30, s46
    s_add_u32 m0, s37, 14336
    s_nop 0
    buffer_load_dwordx4 v4, s[12:15], s30 offen lds
    s_add_u32 s30, s30, s46
    s_add_u32 s48, s48, s47
    s_add_u32 s49, s49, 1
    s_cmp_eq_u32 s49, 9
    s_cselect_b32 s48, s50, s48
    s_add_u32 s37, s37, 32768
    s_and_b32 s37, s37, 0x1ffff
    s_waitcnt vmcnt(8)
    s_barrier
    s_mov_b32 s30, s48
    s_add_u32 m0, s37, 0
    s_nop 0
    buffer_load_dwordx4 v4, s[12:15], s30 offen lds
    s_add_u32 s30, s30, s46
    s_add_u32 m0, s37, 2048
    s_nop 0
    buffer_load_dwordx4 v4, s[12:15], s30 offen lds
    s_add_u32 s30, s30, s46
    s_add_u32 m0, s37, 4096
    s_nop 0
    buffer_load_dwordx4 v4, s[12:15], s30 offen lds
    s_add_u32 s30, s30, s46
    s_add_u32 m0, s37, 6144
    s_nop 0
    buffer_load_dwordx4 v4, s[12:15], s30 offen lds
    s_add_u32 s30, s30, s46
    s_add_u32 m0, s37, 8192
    s_nop 0
    buffer_load_dwordx4 v4, s[12:15], s30 offen lds
    s_add_u32 s30, s30, s46
    s_add_u32 m0, s37, 10240
    s_nop 0
    buffer_load_dwordx4 v4, s[12:15], s30 offen lds
    s_add_u32 s30, s30, s46
    s_add_u32 m0, s37, 12288
    s_nop 0
    buffer_load_dwordx4 v4, s[12:15], s30 offen lds
    s_add_u32 s30, s30, s46
    s_add_u32 m0, s37, 14336
    s_nop 0
    buffer_load_dwordx4 v4, s[12:15], s30 offen lds
    s_add_u32 s30, s30, s46
    s_add_u32 s48, s48, s47
    s_add_u32 s49, s49, 1
    s_cmp_eq_u32 s49, 9
    s_cselect_b32 s48, s50, s48
    s_add_u32 s37, s37, 32768
    s_and_b32 s37, s37, 0x1ffff
    s_mov_b32 s36, 3
k1_qkv_kernel_lp:
    s_mov_b32 s30, s48
    s_add_u32 m0, s37, 0
    s_nop 0
    buffer_load_dwordx4 v4, s[12:15], s30 offen lds
    s_add_u32 s30, s30, s46
    s_add_u32 m0, s37, 2048
    s_nop 0
    buffer_load_dwordx4 v4, s[12:15], s30 offen lds
    s_add_u32 s30, s30, s46
    s_add_u32 m0, s37, 4096
    s_nop 0
    buffer_load_dwordx4 v4, s[12:15], s30 offen lds
    s_add_u32 s30, s30, s46
    s_add_u32 m0, s37, 6144
    s_nop 0
    buffer_load_dwordx4 v4, s[12:15], s30 offen lds
    s_add_u32 s30, s30, s46
    s_add_u32 m0, s37, 8192
    s_nop 0
    buffer_load_dwordx4 v4, s[12:15], s30 offen lds
    s_add_u32 s30, s30, s46
    s_add_u32 m0, s37, 10240
    s_nop 0
    buffer_load_dwordx4 v4, s[12:15], s30 offen lds
    s_add_u32 s30, s30, s46
    s_add_u32 m0, s37, 12288
    s_nop 0
    buffer_load_dwordx4 v4, s[12:15], s30 offen lds
    s_add_u32 s30, s30, s46
    s_add_u32 m0, s37, 14336
    s_nop 0
    buffer_load_dwordx4 v4, s[12:15], s30 offen lds
    s_add_u32 s30, s30, s46
    s_add_u32 s48, s48, s47
    s_add_u32 s49, s49, 1
    s_cmp_eq_u32 s49, 9
    s_cselect_b32 s48, s50, s48
    s_add_u32 s37, s37, 32768
    s_and_b32 s37, s37, 0x1ffff
    s_add_u32 s36, s36, 1
    s_waitcnt vmcnt(16)
    s_barrier
    s_cmp_lt_u32 s36, 9
    s_cbranch_scc1 k1_qkv_kernel_lp
    s_mov_b64 exec, -1
    s_mov_b32 s20, s8
    s_mov_b32 s21, s9
    s_mov_b32 s22, 17825792
    s_mov_b32 s23, 0x00020000
    s_mov_b32 s16, s74
    s_mov_b32 s17, s75
    s_mov_b32 s18, 256
    s_mov_b32 s19, 0x00020000
    s_lshl_b32 s42, s25, 14
    s_add_u32 s42, s42, 7602176
    s_lshl_b32 s43, s24, 14
    s_add_u32 s43, s43, 10747904
    s_cmp_eq_u32 s45, 1
    s_cselect_b32 s42, s43, s42
    s_lshl_b32 s30, s44, 9
    v_lshl_add_u32 v20, v1, 3, s30
    s_waitcnt vmcnt(8)
    s_barrier
    v_mov_b32 v16, 0
    s_mov_b32 s31, 0
k1_qkv_kernel_tk2:
    buffer_load_dword v17, v16, s[16:19], 0 offen sc1
    s_add_u32 s31, s31, 1
    s_waitcnt vmcnt(0)
    v_readfirstlane_b32 s73, v17
    s_nop 0
    s_cmp_lg_u32 s73, 0
    s_cbranch_scc1 k1_qkv_kernel_tkd2
    s_sleep 2
    s_cmp_lt_u32 s31, 40000
    s_cbranch_scc1 k1_qkv_kernel_tk2
k1_qkv_kernel_tkd2:
    s_barrier
    s_mov_b32 s31, 0
k1_qkv_kernel_fp:
    s_mov_b32 s43, s42
    buffer_load_dwordx2 v[24:25], v20, s[20:23], s43 offen offset:0 sc1
    buffer_load_dwordx2 v[26:27], v20, s[20:23], s43 offen offset:1024 sc1
    buffer_load_dwordx2 v[28:29], v20, s[20:23], s43 offen offset:2048 sc1
    buffer_load_dwordx2 v[30:31], v20, s[20:23], s43 offen offset:3072 sc1
    s_add_u32 s43, s43, 4096
    buffer_load_dwordx2 v[32:33], v20, s[20:23], s43 offen offset:0 sc1
    buffer_load_dwordx2 v[34:35], v20, s[20:23], s43 offen offset:1024 sc1
    buffer_load_dwordx2 v[36:37], v20, s[20:23], s43 offen offset:2048 sc1
    buffer_load_dwordx2 v[38:39], v20, s[20:23], s43 offen offset:3072 sc1
    s_add_u32 s43, s43, 4096
    buffer_load_dwordx2 v[40:41], v20, s[20:23], s43 offen offset:0 sc1
    s_cmp_lg_u32 s31, 0
    s_cbranch_scc1 k1_qkv_kernel_nb9
    s_barrier
k1_qkv_kernel_nb9:
    s_add_u32 s31, s31, 1
    s_waitcnt vmcnt(0)
    v_xor_b32 v16, s73, v25
    v_xor_b32 v17, s73, v27
    v_or_b32 v16, v16, v17
    v_xor_b32 v17, s73, v29
    v_or_b32 v16, v16, v17
    v_xor_b32 v17, s73, v31
    v_or_b32 v16, v16, v17
    v_xor_b32 v17, s73, v33
    v_or_b32 v16, v16, v17
    v_xor_b32 v17, s73, v35
    v_or_b32 v16, v16, v17
    v_xor_b32 v17, s73, v37
    v_or_b32 v16, v16, v17
    v_xor_b32 v17, s73, v39
    v_or_b32 v16, v16, v17
    v_xor_b32 v17, s73, v41
    v_or_b32 v16, v16, v17
    v_cmp_ne_u32 vcc, 0, v16
    s_cmp_gt_u32 s31, 20000
    s_cbranch_scc1 k1_qkv_kernel_fd
    s_cbranch_vccnz k1_qkv_kernel_fp
k1_qkv_kernel_fd:
    s_lshl_b32 s30, s45, 9
    s_add_u32 s30, s30, 131072
    v_lshrrev_b32 v20, 1, v20
    v_add_u32 v20, s30, v20
    v_add_f32 v24, v24, v26
    v_add_f32 v24, v24, v28
    v_add_f32 v24, v24, v30
    v_add_f32 v24, v24, v32
    v_add_f32 v24, v24, v34
    v_add_f32 v24, v24, v36
    v_add_f32 v24, v24, v38
    v_add_f32 v24, v24, v40
    ds_write_b32 v20, v24
    s_waitcnt lgkmcnt(0)
    s_barrier
k1_qkv_kernel_end:
    s_endpgm
k1_qkv_kernel_comp:
    s_and_b32 s40, s26, 1
    s_bfe_u32 s41, s26, 0x10001
    s_mov_b32 s72, s26
    v_and_b32 v16, 3, v1
    v_lshlrev_b32 v16, 2, v16
    v_xor_b32 v16, 14, v16
    v_lshlrev_b32 v16, 4, v16
    v_lshl_add_u32 v16, v1, 8, v16
    s_and_b32 s30, s26, 3
    s_lshl_b32 s30, s30, 15
    v_add_u32 v17, s30, v16
    v_mov_b32 v18, 0x3f80
    v_mov_b32 v19, 0
    ds_write_b64 v17, v[18:19] offset:16384
    v_mov_b32 v56, 0x3f803f80
    v_mov_b32 v57, 0x3f803f80
    v_mov_b32 v58, 0x3f803f80
    v_mov_b32 v59, 0x3f803f80
    s_lshl_b32 s30, s40, 13
    v_lshlrev_b32 v16, 7, v2
    v_add_u32 v16, s30, v16
    v_bfe_u32 v17, v2, 1, 3
    v_xor_b32 v17, v17, v3
    v_lshl_add_u32 v16, v17, 4, v16
    s_lshl_b32 s30, s41, 12
    v_add_u32 v16, s30, v16
    v_mov_b32 v160, v16
    v_xor_b32 v161, 32, v160
    v_xor_b32 v162, 64, v160
    v_xor_b32 v163, 96, v160
    v_xor_b32 v164, 0x1000, v160
    v_xor_b32 v165, 0x1000, v161
    v_xor_b32 v166, 0x1000, v162
    v_xor_b32 v167, 0x1000, v163
    v_bfe_u32 v20, v1, 2, 2
    v_and_b32 v21, 3, v1
    v_bfe_u32 v22, v1, 4, 1
    v_lshrrev_b32 v17, 1, v21
    v_lshl_add_u32 v17, v22, 1, v17
    v_mul_u32_u24 v18, 72, v17
    v_add_u32 v18, 32, v18
    v_min_u32 v18, 224, v18
    v_mul_u32_u24 v19, 40, v22
    v_lshl_add_u32 v19, v21, 3, v19
    s_xor_b32 s30, s72, 0
    s_mul_i32 s31, s30, 72
    v_add_u32 v16, s31, v19
    s_cmp_eq_u32 s30, 3
    s_cselect_b64 s[34:35], -1, 0
    v_cndmask_b32 v16, v16, v18, s[34:35]
    v_lshlrev_b32 v17, 6, v20
    v_xor_b32 v16, v16, v17
    v_lshl_add_u32 v17, v3, 3, v20
    v_lshl_add_u32 v16, v17, 8, v16
    v_add_u32 v168, 16384, v16
    s_xor_b32 s30, s72, 1
    s_mul_i32 s31, s30, 72
    v_add_u32 v16, s31, v19
    s_cmp_eq_u32 s30, 3
    s_cselect_b64 s[34:35], -1, 0
    v_cndmask_b32 v16, v16, v18, s[34:35]
    v_lshlrev_b32 v17, 6, v20
    v_xor_b32 v16, v16, v17
    v_lshl_add_u32 v17, v3, 3, v20
    v_lshl_add_u32 v16, v17, 8, v16
    v_add_u32 v169, 16384, v16
    s_waitcnt lgkmcnt(0)
    s_mov_b32 s20, s8
    s_mov_b32 s21, s9
    s_mov_b32 s22, 17825792
    s_mov_b32 s23, 0x00020000
    s_mov_b32 s16, s74
    s_mov_b32 s17, s75
    s_mov_b32 s18, 256
    s_mov_b32 s19, 0x00020000
    s_or_b32 s30, s2, s26
    s_cmp_lg_u32 s30, 0
    s_cbranch_scc1 k1_qkv_kernel_ntk
    s_memrealtime s[76:77]
    v_mov_b32 v16, 0
    s_waitcnt lgkmcnt(0)
    s_or_b32 s76, s76, 1
    v_mov_b32 v17, s76
    s_mov_b64 exec, 1
    buffer_store_dword v17, v16, s[16:19], 0 offen sc1
    s_mov_b64 exec, -1
k1_qkv_kernel_ntk:
    v_mov_b32 v64, 0
    v_mov_b32 v65, 0
    v_mov_b32 v66, 0
    v_mov_b32 v67, 0
    v_mov_b32 v68, 0
    v_mov_b32 v69, 0
    v_mov_b32 v70, 0
    v_mov_b32 v71, 0
    v_mov_b32 v72, 0
    v_mov_b32 v73, 0
    v_mov_b32 v74, 0
    v_mov_b32 v75, 0
    v_mov_b32 v76, 0
    v_mov_b32 v77, 0
    v_mov_b32 v78, 0
    v_mov_b32 v79, 0
    v_mov_b32 v80, 0
    v_mov_b32 v81, 0
    v_mov_b32 v82, 0
    v_mov_b32 v83, 0
    v_mov_b32 v84, 0
    v_mov_b32 v85, 0
    v_mov_b32 v86, 0
    v_mov_b32 v87, 0
    v_mov_b32 v88, 0
    v_mov_b32 v89, 0
    v_mov_b32 v90, 0
    v_mov_b32 v91, 0
    v_mov_b32 v92, 0
    v_mov_b32 v93, 0
    v_mov_b32 v94, 0
    v_mov_b32 v95, 0
    v_mov_b32 v96, 0
    v_mov_b32 v97, 0
    v_mov_b32 v98, 0
    v_mov_b32 v99, 0
    v_mov_b32 v100, 0
    v_mov_b32 v101, 0
    v_mov_b32 v102, 0
    v_mov_b32 v103, 0
    v_mov_b32 v104, 0
    v_mov_b32 v105, 0
    v_mov_b32 v106, 0
    v_mov_b32 v107, 0
    v_mov_b32 v108, 0
    v_mov_b32 v109, 0
    v_mov_b32 v110, 0
    v_mov_b32 v111, 0
    v_mov_b32 v112, 0
    v_mov_b32 v113, 0
    v_mov_b32 v114, 0
    v_mov_b32 v115, 0
    v_mov_b32 v116, 0
    v_mov_b32 v117, 0
    v_mov_b32 v118, 0
    v_mov_b32 v119, 0
    v_mov_b32 v120, 0
    v_mov_b32 v121, 0
    v_mov_b32 v122, 0
    v_mov_b32 v123, 0
    v_mov_b32 v124, 0
    v_mov_b32 v125, 0
    v_mov_b32 v126, 0
    v_mov_b32 v127, 0
    v_mov_b32 v128, 0
    v_mov_b32 v129, 0
    v_mov_b32 v130, 0
    v_mov_b32 v131, 0
    v_mov_b32 v132, 0
    v_mov_b32 v133, 0
    v_mov_b32 v134, 0
    v_mov_b32 v135, 0
    v_mov_b32 v136, 0
    v_mov_b32 v137, 0
    v_mov_b32 v138, 0
    v_mov_b32 v139, 0
    v_mov_b32 v140, 0
    v_mov_b32 v141, 0
    v_mov_b32 v142, 0
    v_mov_b32 v143, 0
    v_mov_b32 v144, 0
    v_mov_b32 v145, 0
    v_mov_b32 v146, 0
    v_mov_b32 v147, 0
    v_mov_b32 v148, 0
    v_mov_b32 v149, 0
    v_mov_b32 v150, 0
    v_mov_b32 v151, 0
    v_mov_b32 v152, 0
    v_mov_b32 v153, 0
    v_mov_b32 v154, 0
    v_mov_b32 v155, 0
    v_mov_b32 v156, 0
    v_mov_b32 v157, 0
    v_mov_b32 v158, 0
    v_mov_b32 v159, 0
    s_mul_i32 s30, s24, 3
    s_add_u32 s30, s30, 0
    s_lshr_b32 s53, s30, 4
    s_and_b32 s30, s30, 15
    s_cmp_eq_u32 s53, 0
    s_cselect_b32 s50, 0x3eae1a93, 1.0
    s_mov_b32 s47, 155648
    s_cselect_b32 s47, 73728, s47
    s_cselect_b32 s44, 5242880, 0
    s_lshl_b32 s30, s30, 1
    s_mul_i32 s30, s30, s47
    s_add_u32 s44, s44, s30
    s_mul_i32 s30, s24, 3
    s_add_u32 s30, s30, 1
    s_lshr_b32 s54, s30, 4
    s_and_b32 s30, s30, 15
    s_cmp_eq_u32 s54, 0
    s_cselect_b32 s51, 0x3eae1a93, 1.0
    s_mov_b32 s48, 155648
    s_cselect_b32 s48, 73728, s48
    s_cselect_b32 s45, 5242880, 0
    s_lshl_b32 s30, s30, 1
    s_mul_i32 s30, s30, s48
    s_add_u32 s45, s45, s30
    s_mul_i32 s30, s24, 3
    s_add_u32 s30, s30, 2
    s_lshr_b32 s55, s30, 4
    s_and_b32 s30, s30, 15
    s_cmp_eq_u32 s55, 0
    s_cselect_b32 s52, 0x3eae1a93, 1.0
    s_mov_b32 s49, 155648
    s_cselect_b32 s49, 73728, s49
    s_cselect_b32 s46, 5242880, 0
    s_lshl_b32 s30, s30, 1
    s_mul_i32 s30, s30, s49
    s_add_u32 s46, s46, s30
    s_xor_b32 s30, s41, 0
    s_lshl_b32 s31, s40, 1
    s_add_u32 s30, s30, s31
    s_lshl_b32 s31, s25, 2
    s_add_u32 s30, s30, s31
    s_lshl_b32 s56, s30, 10
    s_lshl_b32 s59, s30, 7
    s_add_u32 s59, s59, 65536
    s_lshr_b32 s31, s30, 3
    s_mul_i32 s31, s31, 19456
    s_and_b32 s30, s30, 7
    s_lshl_b32 s57, s30, 10
    s_add_u32 s57, s57, s31
    s_mul_i32 s58, s30, 1280
    s_add_u32 s58, s58, s31
    s_add_u32 s58, s58, 9216
    s_lshl_b32 s60, s30, 7
    s_add_u32 s60, s60, s31
    s_add_u32 s60, s60, 8192
    s_xor_b32 s30, s41, 1
    s_lshl_b32 s31, s40, 1
    s_add_u32 s30, s30, s31
    s_lshl_b32 s31, s25, 2
    s_add_u32 s30, s30, s31
    s_lshl_b32 s61, s30, 10
    s_lshl_b32 s64, s30, 7
    s_add_u32 s64, s64, 65536
    s_lshr_b32 s31, s30, 3
    s_mul_i32 s31, s31, 19456
    s_and_b32 s30, s30, 7
    s_lshl_b32 s62, s30, 10
    s_add_u32 s62, s62, s31
    s_mul_i32 s63, s30, 1280
    s_add_u32 s63, s63, s31
    s_add_u32 s63, s63, 9216
    s_lshl_b32 s65, s30, 7
    s_add_u32 s65, s65, s31
    s_add_u32 s65, s65, 8192
    s_cmp_eq_u32 s53, 0
    s_cselect_b32 s4, s59, s60
    s_cmp_eq_u32 s53, 2
    s_cselect_b32 s4, s58, s4
    s_add_u32 s4, s4, s44
    s_cmp_eq_u32 s53, 0
    s_cselect_b32 s5, s64, s65
    s_cmp_eq_u32 s53, 2
    s_cselect_b32 s5, s63, s5
    s_add_u32 s5, s5, s44
    s_cmp_eq_u32 s54, 0
    s_cselect_b32 s6, s59, s60
    s_cmp_eq_u32 s54, 2
    s_cselect_b32 s6, s58, s6
    s_add_u32 s6, s6, s45
    s_cmp_eq_u32 s54, 0
    s_cselect_b32 s7, s64, s65
    s_cmp_eq_u32 s54, 2
    s_cselect_b32 s7, s63, s7
    s_add_u32 s7, s7, s45
    s_cmp_eq_u32 s55, 0
    s_cselect_b32 s8, s59, s60
    s_cmp_eq_u32 s55, 2
    s_cselect_b32 s8, s58, s8
    s_add_u32 s8, s8, s46
    s_cmp_eq_u32 s55, 0
    s_cselect_b32 s9, s64, s65
    s_cmp_eq_u32 s55, 2
    s_cselect_b32 s9, s63, s9
    s_add_u32 s9, s9, s46
    s_xor_b32 s30, s72, 0
    s_cmp_eq_u32 s30, 1
    s_cselect_b32 s42, s45, s44
    s_cselect_b32 s70, s48, s47
    s_cselect_b32 s98, s51, s50
    s_cselect_b32 s100, s54, s53
    s_cmp_eq_u32 s30, 2
    s_cselect_b32 s42, s46, s42
    s_cselect_b32 s70, s49, s70
    s_cselect_b32 s98, s52, s98
    s_cselect_b32 s100, s55, s100
    s_cmp_eq_u32 s30, 3
    s_cselect_b32 s100, 3, s100
    s_cmp_eq_u32 s100, 0
    s_cselect_b32 s66, s56, s57
    s_cmp_eq_u32 s100, 2
    s_cselect_b32 s66, s58, s66
    s_add_u32 s66, s66, s42
    s_cmp_eq_u32 s100, 0
    s_cselect_b32 s67, s61, s62
    s_cmp_eq_u32 s100, 2
    s_cselect_b32 s67, s63, s67
    s_add_u32 s67, s67, s42
    s_xor_b32 s30, s72, 1
    s_cmp_eq_u32 s30, 1
    s_cselect_b32 s42, s45, s44
    s_cselect_b32 s71, s48, s47
    s_cselect_b32 s99, s51, s50
    s_cselect_b32 s101, s54, s53
    s_cmp_eq_u32 s30, 2
    s_cselect_b32 s42, s46, s42
    s_cselect_b32 s71, s49, s71
    s_cselect_b32 s99, s52, s99
    s_cselect_b32 s101, s55, s101
    s_cmp_eq_u32 s30, 3
    s_cselect_b32 s101, 3, s101
    s_cmp_eq_u32 s101, 0
    s_cselect_b32 s68, s56, s57
    s_cmp_eq_u32 s101, 2
    s_cselect_b32 s68, s58, s68
    s_add_u32 s68, s68, s42
    s_cmp_eq_u32 s101, 0
    s_cselect_b32 s69, s61, s62
    s_cmp_eq_u32 s101, 2
    s_cselect_b32 s69, s63, s69
    s_add_u32 s69, s69, s42
    s_cmp_gt_u32 s26, 3
    s_cbranch_scc1 k1_qkv_kernel_ny
    v_min_u32 v16, 157, v0
    v_lshlrev_b32 v16, 4, v16
    s_mul_i32 s30, s2, 2528
    s_add_u32 s30, s30, 14745600
    s_lshl_b32 s31, s2, 4
    s_add_u32 s31, s31, 14704640
    s_cmp_eq_u32 s26, 3
    s_cselect_b32 s30, s31, s30
    s_cselect_b32 s31, 0, -1
    v_and_b32 v16, s31, v16
    v_mov_b32 v20, s31
    v_mov_b32 v21, s31
    v_mov_b32 v22, s31
    v_mov_b32 v23, s31
    buffer_store_dwordx4 v[20:23], v16, s[20:23], s30 offen
k1_qkv_kernel_ny:
    s_waitcnt lgkmcnt(0)
    s_barrier
    v_mov_b32 v13, 0
    buffer_load_dword v14, v13, s[16:19], 0 offen sc1
    ds_read_b128 v[24:27], v160
    ds_read_b64_tr_b16 v[40:41], v168 offset:0
    ds_read_b64_tr_b16 v[42:43], v168 offset:1024
    ds_read_b128 v[28:31], v164
    ds_read_b64_tr_b16 v[44:45], v169 offset:0
    ds_read_b64_tr_b16 v[46:47], v169 offset:1024
    ds_read_b128 v[32:35], v161
    ds_read_b64_tr_b16 v[48:49], v168 offset:4096
    ds_read_b64_tr_b16 v[50:51], v168 offset:5120
    ds_read_b128 v[36:39], v165
    ds_read_b64_tr_b16 v[52:53], v169 offset:4096
    ds_read_b64_tr_b16 v[54:55], v169 offset:5120
    s_waitcnt lgkmcnt(6)
    v_mfma_f32_32x32x16_bf16 v[64:79], v[40:43], v[24:27], v[64:79]
    ds_read_b128 v[172:175], v162
    ds_read_b64_tr_b16 v[188:189], v168 offset:8192
    v_mfma_f32_32x32x16_bf16 v[80:95], v[40:43], v[28:31], v[80:95]
    ds_read_b64_tr_b16 v[190:191], v168 offset:9216
    ds_read_b128 v[176:179], v166
    v_mfma_f32_32x32x16_bf16 v[96:111], v[44:47], v[24:27], v[96:111]
    ds_read_b64_tr_b16 v[192:193], v169 offset:8192
    ds_read_b64_tr_b16 v[194:195], v169 offset:9216
    v_mfma_f32_32x32x16_bf16 v[112:127], v[44:47], v[28:31], v[112:127]
    v_mfma_f32_32x32x16_bf16 v[128:143], v[24:27], v[24:27], v[128:143]
    v_mfma_f32_32x32x16_bf16 v[144:159], v[40:43], v[56:59], v[144:159]
    s_waitcnt lgkmcnt(6)
    v_mfma_f32_32x32x16_bf16 v[64:79], v[48:51], v[32:35], v[64:79]
    ds_read_b128 v[180:183], v163
    ds_read_b64_tr_b16 v[196:197], v168 offset:12288
    v_mfma_f32_32x32x16_bf16 v[80:95], v[48:51], v[36:39], v[80:95]
    ds_read_b64_tr_b16 v[198:199], v168 offset:13312
    ds_read_b128 v[184:187], v167
    v_mfma_f32_32x32x16_bf16 v[96:111], v[52:55], v[32:35], v[96:111]
    ds_read_b64_tr_b16 v[200:201], v169 offset:12288
    ds_read_b64_tr_b16 v[202:203], v169 offset:13312
    v_mfma_f32_32x32x16_bf16 v[112:127], v[52:55], v[36:39], v[112:127]
    v_mfma_f32_32x32x16_bf16 v[128:143], v[32:35], v[32:35], v[128:143]
    v_mfma_f32_32x32x16_bf16 v[144:159], v[48:51], v[56:59], v[144:159]
    s_waitcnt lgkmcnt(6)
    v_mfma_f32_32x32x16_bf16 v[64:79], v[188:191], v[172:175], v[64:79]
    v_add_u32 v160, 32768, v160
    v_and_b32 v160, 0x1ffff, v160
    v_add_u32 v161, 32768, v161
    v_and_b32 v161, 0x1ffff, v161
    v_add_u32 v162, 32768, v162
    v_mfma_f32_32x32x16_bf16 v[80:95], v[188:191], v[176:179], v[80:95]
    v_and_b32 v162, 0x1ffff, v162
    v_add_u32 v163, 32768, v163
    v_and_b32 v163, 0x1ffff, v163
    v_add_u32 v164, 32768, v164
    v_and_b32 v164, 0x1ffff, v164
    v_mfma_f32_32x32x16_bf16 v[96:111], v[192:195], v[172:175], v[96:111]
    v_add_u32 v165, 32768, v165
    v_and_b32 v165, 0x1ffff, v165
    v_add_u32 v166, 32768, v166
    v_and_b32 v166, 0x1ffff, v166
    v_add_u32 v167, 32768, v167
    v_mfma_f32_32x32x16_bf16 v[112:127], v[192:195], v[176:179], v[112:127]
    v_and_b32 v167, 0x1ffff, v167
    v_add_u32 v168, 32768, v168
    v_and_b32 v168, 0x1ffff, v168
    v_add_u32 v169, 32768, v169
    v_and_b32 v169, 0x1ffff, v169
    v_mfma_f32_32x32x16_bf16 v[128:143], v[172:175], v[172:175], v[128:143]
    v_mfma_f32_32x32x16_bf16 v[144:159], v[188:191], v[56:59], v[144:159]
    s_waitcnt lgkmcnt(0)
    s_barrier
    v_mfma_f32_32x32x16_bf16 v[64:79], v[196:199], v[180:183], v[64:79]
    ds_read_b128 v[24:27], v160
    ds_read_b64_tr_b16 v[40:41], v168 offset:0
    ds_read_b64_tr_b16 v[42:43], v168 offset:1024
    v_mfma_f32_32x32x16_bf16 v[80:95], v[196:199], v[184:187], v[80:95]
    ds_read_b128 v[28:31], v164
    ds_read_b64_tr_b16 v[44:45], v169 offset:0
    ds_read_b64_tr_b16 v[46:47], v169 offset:1024
    v_mfma_f32_32x32x16_bf16 v[96:111], v[200:203], v[180:183], v[96:111]
    ds_read_b128 v[32:35], v161
    ds_read_b64_tr_b16 v[48:49], v168 offset:4096
    ds_read_b64_tr_b16 v[50:51], v168 offset:5120
    v_mfma_f32_32x32x16_bf16 v[112:127], v[200:203], v[184:187], v[112:127]
    ds_read_b128 v[36:39], v165
    ds_read_b64_tr_b16 v[52:53], v169 offset:4096
    ds_read_b64_tr_b16 v[54:55], v169 offset:5120
    v_mfma_f32_32x32x16_bf16 v[128:143], v[180:183], v[180:183], v[128:143]
    v_mfma_f32_32x32x16_bf16 v[144:159], v[196:199], v[56:59], v[144:159]
    s_waitcnt vmcnt(0)
    v_readfirstlane_b32 s73, v14
    s_nop 0
    s_cmp_lg_u32 s73, 0
    s_cbranch_scc1 k1_qkv_kernel_htk
    v_mov_b32 v16, 0
    s_mov_b32 s31, 0
k1_qkv_kernel_tk1:
    buffer_load_dword v17, v16, s[16:19], 0 offen sc1
    s_add_u32 s31, s31, 1
    s_waitcnt vmcnt(0)
    v_readfirstlane_b32 s73, v17
    s_nop 0
    s_cmp_lg_u32 s73, 0
    s_cbranch_scc1 k1_qkv_kernel_tkd1
    s_sleep 2
    s_cmp_lt_u32 s31, 40000
    s_cbranch_scc1 k1_qkv_kernel_tk1
k1_qkv_kernel_tkd1:
k1_qkv_kernel_htk:
    v_lshrrev_b32 v16, 3, v2
    v_and_b32 v17, 3, v2
    v_lshl_add_u32 v16, v16, 2, v17
    s_lshl_b32 s42, s25, 4
    s_add_u32 s42, s42, s24
    s_lshl_b32 s42, s42, 10
    s_lshl_b32 s31, s40, 1
    s_add_u32 s31, s31, s41
    s_lshl_b32 s31, s31, 8
    s_add_u32 s42, s42, s31
    s_add_u32 s42, s42, 7602176
    s_lshl_b32 s43, s24, 4
    s_add_u32 s43, s43, s25
    s_lshl_b32 s43, s43, 10
    s_lshl_b32 s31, s72, 8
    s_add_u32 s43, s43, s31
    s_add_u32 s43, s43, 10747904
    v_mov_b32 v20, v128
    v_mov_b32 v22, v144
    v_mov_b32 v21, s73
    v_mov_b32 v23, s73
    v_cmp_eq_u32 vcc, 1, v16
    s_nop 1
    v_cndmask_b32 v20, v20, v129, vcc
    v_cndmask_b32 v22, v22, v145, vcc
    v_cmp_eq_u32 vcc, 2, v16
    s_nop 1
    v_cndmask_b32 v20, v20, v130, vcc
    v_cndmask_b32 v22, v22, v146, vcc
    v_cmp_eq_u32 vcc, 3, v16
    s_nop 1
    v_cndmask_b32 v20, v20, v131, vcc
    v_cndmask_b32 v22, v22, v147, vcc
    v_cmp_eq_u32 vcc, 4, v16
    s_nop 1
    v_cndmask_b32 v20, v20, v132, vcc
    v_cndmask_b32 v22, v22, v148, vcc
    v_cmp_eq_u32 vcc, 5, v16
    s_nop 1
    v_cndmask_b32 v20, v20, v133, vcc
    v_cndmask_b32 v22, v22, v149, vcc
    v_cmp_eq_u32 vcc, 6, v16
    s_nop 1
    v_cndmask_b32 v20, v20, v134, vcc
    v_cndmask_b32 v22, v22, v150, vcc
    v_cmp_eq_u32 vcc, 7, v16
    s_nop 1
    v_cndmask_b32 v20, v20, v135, vcc
    v_cndmask_b32 v22, v22, v151, vcc
    v_cmp_eq_u32 vcc, 8, v16
    s_nop 1
    v_cndmask_b32 v20, v20, v136, vcc
    v_cndmask_b32 v22, v22, v152, vcc
    v_cmp_eq_u32 vcc, 9, v16
    s_nop 1
    v_cndmask_b32 v20, v20, v137, vcc
    v_cndmask_b32 v22, v22, v153, vcc
    v_cmp_eq_u32 vcc, 10, v16
    s_nop 1
    v_cndmask_b32 v20, v20, v138, vcc
    v_cndmask_b32 v22, v22, v154, vcc
    v_cmp_eq_u32 vcc, 11, v16
    s_nop 1
    v_cndmask_b32 v20, v20, v139, vcc
    v_cndmask_b32 v22, v22, v155, vcc
    v_cmp_eq_u32 vcc, 12, v16
    s_nop 1
    v_cndmask_b32 v20, v20, v140, vcc
    v_cndmask_b32 v22, v22, v156, vcc
    v_cmp_eq_u32 vcc, 13, v16
    s_nop 1
    v_cndmask_b32 v20, v20, v141, vcc
    v_cndmask_b32 v22, v22, v157, vcc
    v_cmp_eq_u32 vcc, 14, v16
    s_nop 1
    v_cndmask_b32 v20, v20, v142, vcc
    v_cndmask_b32 v22, v22, v158, vcc
    v_cmp_eq_u32 vcc, 15, v16
    s_nop 1
    v_cndmask_b32 v20, v20, v143, vcc
    v_cndmask_b32 v22, v22, v159, vcc
    v_lshlrev_b32 v16, 3, v2
    v_bfe_u32 v18, v2, 2, 1
    v_cmp_eq_u32 vcc, v18, v3
    s_nop 0
    s_and_saveexec_b64 s[34:35], vcc
    buffer_store_dwordx2 v[20:21], v16, s[20:23], s42 offen sc1
    buffer_store_dwordx2 v[22:23], v16, s[20:23], s43 offen sc1
    s_mov_b64 exec, -1
    s_mov_b32 s36, 1
k1_qkv_kernel_loop:
    s_waitcnt lgkmcnt(6)
    v_mfma_f32_32x32x16_bf16 v[64:79], v[40:43], v[24:27], v[64:79]
    ds_read_b128 v[172:175], v162
    ds_read_b64_tr_b16 v[188:189], v168 offset:8192
    v_mfma_f32_32x32x16_bf16 v[80:95], v[40:43], v[28:31], v[80:95]
    ds_read_b64_tr_b16 v[190:191], v168 offset:9216
    ds_read_b128 v[176:179], v166
    v_mfma_f32_32x32x16_bf16 v[96:111], v[44:47], v[24:27], v[96:111]
    ds_read_b64_tr_b16 v[192:193], v169 offset:8192
    ds_read_b64_tr_b16 v[194:195], v169 offset:9216
    v_mfma_f32_32x32x16_bf16 v[112:127], v[44:47], v[28:31], v[112:127]
    s_waitcnt lgkmcnt(6)
    v_mfma_f32_32x32x16_bf16 v[64:79], v[48:51], v[32:35], v[64:79]
    ds_read_b128 v[180:183], v163
    ds_read_b64_tr_b16 v[196:197], v168 offset:12288
    v_mfma_f32_32x32x16_bf16 v[80:95], v[48:51], v[36:39], v[80:95]
    ds_read_b64_tr_b16 v[198:199], v168 offset:13312
    ds_read_b128 v[184:187], v167
    v_mfma_f32_32x32x16_bf16 v[96:111], v[52:55], v[32:35], v[96:111]
    ds_read_b64_tr_b16 v[200:201], v169 offset:12288
    ds_read_b64_tr_b16 v[202:203], v169 offset:13312
    v_mfma_f32_32x32x16_bf16 v[112:127], v[52:55], v[36:39], v[112:127]
    s_waitcnt lgkmcnt(6)
    v_mfma_f32_32x32x16_bf16 v[64:79], v[188:191], v[172:175], v[64:79]
    v_add_u32 v160, 32768, v160
    v_and_b32 v160, 0x1ffff, v160
    v_add_u32 v161, 32768, v161
    v_and_b32 v161, 0x1ffff, v161
    v_add_u32 v162, 32768, v162
    v_mfma_f32_32x32x16_bf16 v[80:95], v[188:191], v[176:179], v[80:95]
    v_and_b32 v162, 0x1ffff, v162
    v_add_u32 v163, 32768, v163
    v_and_b32 v163, 0x1ffff, v163
    v_add_u32 v164, 32768, v164
    v_and_b32 v164, 0x1ffff, v164
    v_mfma_f32_32x32x16_bf16 v[96:111], v[192:195], v[172:175], v[96:111]
    v_add_u32 v165, 32768, v165
    v_and_b32 v165, 0x1ffff, v165
    v_add_u32 v166, 32768, v166
    v_and_b32 v166, 0x1ffff, v166
    v_add_u32 v167, 32768, v167
    v_mfma_f32_32x32x16_bf16 v[112:127], v[192:195], v[176:179], v[112:127]
    v_and_b32 v167, 0x1ffff, v167
    v_add_u32 v168, 32768, v168
    v_and_b32 v168, 0x1ffff, v168
    v_add_u32 v169, 32768, v169
    v_and_b32 v169, 0x1ffff, v169
    s_waitcnt lgkmcnt(0)
    s_barrier
    v_mfma_f32_32x32x16_bf16 v[64:79], v[196:199], v[180:183], v[64:79]
    ds_read_b128 v[24:27], v160
    ds_read_b64_tr_b16 v[40:41], v168 offset:0
    ds_read_b64_tr_b16 v[42:43], v168 offset:1024
    v_mfma_f32_32x32x16_bf16 v[80:95], v[196:199], v[184:187], v[80:95]
    ds_read_b128 v[28:31], v164
    ds_read_b64_tr_b16 v[44:45], v169 offset:0
    ds_read_b64_tr_b16 v[46:47], v169 offset:1024
    v_mfma_f32_32x32x16_bf16 v[96:111], v[200:203], v[180:183], v[96:111]
    ds_read_b128 v[32:35], v161
    ds_read_b64_tr_b16 v[48:49], v168 offset:4096
    ds_read_b64_tr_b16 v[50:51], v168 offset:5120
    v_mfma_f32_32x32x16_bf16 v[112:127], v[200:203], v[184:187], v[112:127]
    ds_read_b128 v[36:39], v165
    ds_read_b64_tr_b16 v[52:53], v169 offset:4096
    ds_read_b64_tr_b16 v[54:55], v169 offset:5120
    s_add_u32 s36, s36, 1
    s_cmp_lt_u32 s36, 9
    s_cbranch_scc1 k1_qkv_kernel_loop
    v_lshlrev_b32 v4, 4, v1
    s_lshl_b32 s42, s40, 1
    s_add_u32 s42, s42, s41
    s_lshl_b32 s42, s42, 7
    s_add_u32 s42, s42, 131072
    v_lshlrev_b32 v16, 2, v2
    v_add_u32 v17, s42, v16
    s_lshl_b32 s43, s72, 7
    s_add_u32 s43, s43, 131072
    v_xor_b32 v18, 128, v17
    s_cmp_eq_u32 s41, 0
    s_cbranch_scc1 k1_qkv_kernel_nosx
    s_cmp_eq_u32 s72, 3
    s_cselect_b64 s[34:35], -1, 0
    v_cndmask_b32 v19, v108, v76, s[34:35]
    v_cndmask_b32 v12, v124, v92, s[34:35]
    ds_write_b32 v17, v19 offset:1024
    ds_write_b32 v18, v12 offset:1024
k1_qkv_kernel_nosx:
    v_lshl_add_u32 v20, v3, 4, s43
    v_xor_b32 v21, 128, v20
    v_lshrrev_b32 v5, 3, v2
    v_mul_u32_u24 v5, 320, v5
    v_lshlrev_b32 v6, 2, v2
    v_and_b32 v8, 7, v2
    v_lshl_add_u32 v7, v8, 3, v5
    v_add_u32 v7, 128, v7
    v_lshl_add_u32 v5, v3, 4, v5
    v_and_b32 v8, 3, v2
    v_lshl_add_u32 v5, v8, 5, v5
    v_bfe_u32 v8, v2, 2, 1
    v_mul_u32_u24 v8, 192, v8
    v_add_u32 v5, v5, v8
    s_waitcnt lgkmcnt(0)
    s_barrier
    ds_read_b32 v48, v17
    ds_read_b32 v49, v17 offset:1024
    ds_read_b32 v50, v18
    ds_read_b32 v51, v18 offset:1024
    ds_read_b128 v[128:131], v20 offset:512
    ds_read_b128 v[132:135], v20 offset:544
    ds_read_b128 v[136:139], v20 offset:576
    ds_read_b128 v[140:143], v20 offset:608
    ds_read_b128 v[144:147], v21 offset:512
    ds_read_b128 v[148:151], v21 offset:544
    ds_read_b128 v[152:155], v21 offset:576
    ds_read_b128 v[156:159], v21 offset:608
    s_waitcnt lgkmcnt(8)
    v_mul_f32 v24, 0x3ae38e39, v49
    v_mul_f32 v19, 0x3ae38e39, v48
    v_fma_f32 v19, -v24, v24, v19
    v_max_f32 v19, 0, v19
    v_cvt_pk_bf16_f32 v19, v19, v19
    v_lshlrev_b32 v19, 16, v19
    v_add_f32 v19, 0x3727c5ac, v19
    v_cvt_pk_bf16_f32 v19, v19, v19
    v_lshlrev_b32 v19, 16, v19
    v_sqrt_f32 v19, v19
    s_nop 0
    v_cvt_pk_bf16_f32 v19, v19, v19
    v_lshlrev_b32 v19, 16, v19
    v_rcp_f32 v28, v19
    v_cvt_pk_bf16_f32 v24, v24, v24
    v_lshlrev_b32 v24, 16, v24
    v_mul_f32 v26, 0x3ae38e39, v51
    v_mul_f32 v19, 0x3ae38e39, v50
    v_fma_f32 v19, -v26, v26, v19
    v_max_f32 v19, 0, v19
    v_cvt_pk_bf16_f32 v19, v19, v19
    v_lshlrev_b32 v19, 16, v19
    v_add_f32 v19, 0x3727c5ac, v19
    v_cvt_pk_bf16_f32 v19, v19, v19
    v_lshlrev_b32 v19, 16, v19
    v_sqrt_f32 v19, v19
    s_nop 0
    v_cvt_pk_bf16_f32 v19, v19, v19
    v_lshlrev_b32 v19, 16, v19
    v_rcp_f32 v29, v19
    v_cvt_pk_bf16_f32 v26, v26, v26
    v_lshlrev_b32 v26, 16, v26
    s_waitcnt lgkmcnt(0)
    v_pk_fma_f32 v[64:65], v[128:129], v[24:25], v[64:65] op_sel_hi:[1,0,1] neg_lo:[0,1,0] neg_hi:[0,1,0]
    v_pk_fma_f32 v[66:67], v[130:131], v[24:25], v[66:67] op_sel_hi:[1,0,1] neg_lo:[0,1,0] neg_hi:[0,1,0]
    v_pk_fma_f32 v[68:69], v[132:133], v[24:25], v[68:69] op_sel_hi:[1,0,1] neg_lo:[0,1,0] neg_hi:[0,1,0]
    v_pk_fma_f32 v[70:71], v[134:135], v[24:25], v[70:71] op_sel_hi:[1,0,1] neg_lo:[0,1,0] neg_hi:[0,1,0]
    v_pk_fma_f32 v[72:73], v[136:137], v[24:25], v[72:73] op_sel_hi:[1,0,1] neg_lo:[0,1,0] neg_hi:[0,1,0]
    v_pk_fma_f32 v[74:75], v[138:139], v[24:25], v[74:75] op_sel_hi:[1,0,1] neg_lo:[0,1,0] neg_hi:[0,1,0]
    v_pk_fma_f32 v[76:77], v[140:141], v[24:25], v[76:77] op_sel_hi:[1,0,1] neg_lo:[0,1,0] neg_hi:[0,1,0]
    v_pk_fma_f32 v[78:79], v[142:143], v[24:25], v[78:79] op_sel_hi:[1,0,1] neg_lo:[0,1,0] neg_hi:[0,1,0]
    v_pk_fma_f32 v[80:81], v[128:129], v[26:27], v[80:81] op_sel_hi:[1,0,1] neg_lo:[0,1,0] neg_hi:[0,1,0]
    v_pk_fma_f32 v[82:83], v[130:131], v[26:27], v[82:83] op_sel_hi:[1,0,1] neg_lo:[0,1,0] neg_hi:[0,1,0]
    v_pk_fma_f32 v[84:85], v[132:133], v[26:27], v[84:85] op_sel_hi:[1,0,1] neg_lo:[0,1,0] neg_hi:[0,1,0]
    v_pk_fma_f32 v[86:87], v[134:135], v[26:27], v[86:87] op_sel_hi:[1,0,1] neg_lo:[0,1,0] neg_hi:[0,1,0]
    v_pk_fma_f32 v[88:89], v[136:137], v[26:27], v[88:89] op_sel_hi:[1,0,1] neg_lo:[0,1,0] neg_hi:[0,1,0]
    v_pk_fma_f32 v[90:91], v[138:139], v[26:27], v[90:91] op_sel_hi:[1,0,1] neg_lo:[0,1,0] neg_hi:[0,1,0]
    v_pk_fma_f32 v[92:93], v[140:141], v[26:27], v[92:93] op_sel_hi:[1,0,1] neg_lo:[0,1,0] neg_hi:[0,1,0]
    v_pk_fma_f32 v[94:95], v[142:143], v[26:27], v[94:95] op_sel_hi:[1,0,1] neg_lo:[0,1,0] neg_hi:[0,1,0]
    s_cmp_eq_u32 s100, 3
    s_cbranch_scc1 k1_qkv_kernel_ext0
    s_cmp_eq_u32 s100, 2
    s_cselect_b64 s[34:35], -1, 0
    v_cndmask_b32 v8, v4, v5, s[34:35]
    v_mul_f32 v30, s98, v28
    s_add_u32 s42, s66, s70
    v_pk_mul_f32 v[64:65], v[64:65], v[30:31] op_sel_hi:[1,0]
    v_pk_mul_f32 v[66:67], v[66:67], v[30:31] op_sel_hi:[1,0]
    v_pk_mul_f32 v[68:69], v[68:69], v[30:31] op_sel_hi:[1,0]
    v_pk_mul_f32 v[70:71], v[70:71], v[30:31] op_sel_hi:[1,0]
    v_pk_mul_f32 v[72:73], v[72:73], v[30:31] op_sel_hi:[1,0]
    v_pk_mul_f32 v[74:75], v[74:75], v[30:31] op_sel_hi:[1,0]
    v_pk_mul_f32 v[76:77], v[76:77], v[30:31] op_sel_hi:[1,0]
    v_pk_mul_f32 v[78:79], v[78:79], v[30:31] op_sel_hi:[1,0]
    v_cvt_pk_bf16_f32 v172, v64, v65
    v_cvt_pk_bf16_f32 v173, v66, v67
    v_cvt_pk_bf16_f32 v174, v68, v69
    v_cvt_pk_bf16_f32 v175, v70, v71
    v_cvt_pk_bf16_f32 v176, v72, v73
    v_cvt_pk_bf16_f32 v177, v74, v75
    v_cvt_pk_bf16_f32 v178, v76, v77
    v_cvt_pk_bf16_f32 v179, v78, v79
    buffer_store_dwordx4 v[172:175], v8, s[20:23], s66 offen
    buffer_store_dwordx4 v[176:179], v8, s[20:23], s42 offen
    v_mul_f32 v30, s98, v29
    s_add_u32 s42, s67, s70
    v_pk_mul_f32 v[80:81], v[80:81], v[30:31] op_sel_hi:[1,0]
    v_pk_mul_f32 v[82:83], v[82:83], v[30:31] op_sel_hi:[1,0]
    v_pk_mul_f32 v[84:85], v[84:85], v[30:31] op_sel_hi:[1,0]
    v_pk_mul_f32 v[86:87], v[86:87], v[30:31] op_sel_hi:[1,0]
    v_pk_mul_f32 v[88:89], v[88:89], v[30:31] op_sel_hi:[1,0]
    v_pk_mul_f32 v[90:91], v[90:91], v[30:31] op_sel_hi:[1,0]
    v_pk_mul_f32 v[92:93], v[92:93], v[30:31] op_sel_hi:[1,0]
    v_pk_mul_f32 v[94:95], v[94:95], v[30:31] op_sel_hi:[1,0]
    v_cvt_pk_bf16_f32 v180, v80, v81
    v_cvt_pk_bf16_f32 v181, v82, v83
    v_cvt_pk_bf16_f32 v182, v84, v85
    v_cvt_pk_bf16_f32 v183, v86, v87
    v_cvt_pk_bf16_f32 v184, v88, v89
    v_cvt_pk_bf16_f32 v185, v90, v91
    v_cvt_pk_bf16_f32 v186, v92, v93
    v_cvt_pk_bf16_f32 v187, v94, v95
    buffer_store_dwordx4 v[180:183], v8, s[20:23], s67 offen
    buffer_store_dwordx4 v[184:187], v8, s[20:23], s42 offen
    s_branch k1_qkv_kernel_done0
k1_qkv_kernel_ext0:
    v_cmp_eq_u32 vcc, 1, v3
    s_cmp_eq_u32 s53, 2
    s_cselect_b64 s[34:35], -1, 0
    v_cndmask_b32 v8, v6, v7, s[34:35]
    v_mul_lo_u32 v16, v3, s47
    v_add_u32 v8, v8, v16
    v_mul_f32 v30, s50, v28
    v_cndmask_b32 v16, v64, v66, vcc
    v_cndmask_b32 v17, v65, v67, vcc
    v_mul_f32 v16, v30, v16
    v_mul_f32 v17, v30, v17
    v_cvt_pk_bf16_f32 v32, v16, v17
    v_mov_b32 v33, 0x3f80
    v_mul_f32 v30, s50, v29
    v_cndmask_b32 v16, v80, v82, vcc
    v_cndmask_b32 v17, v81, v83, vcc
    v_mul_f32 v16, v30, v16
    v_mul_f32 v17, v30, v17
    v_cvt_pk_bf16_f32 v34, v16, v17
    v_mov_b32 v35, 0x3f80
    s_cbranch_scc1 k1_qkv_kernel_e00v
    buffer_store_dword v32, v8, s[20:23], s4 offen
    buffer_store_dword v34, v8, s[20:23], s5 offen
    s_branch k1_qkv_kernel_e00d
k1_qkv_kernel_e00v:
    buffer_store_dwordx2 v[32:33], v8, s[20:23], s4 offen
    buffer_store_dwordx2 v[34:35], v8, s[20:23], s5 offen
k1_qkv_kernel_e00d:
    s_cmp_eq_u32 s54, 2
    s_cselect_b64 s[34:35], -1, 0
    v_cndmask_b32 v8, v6, v7, s[34:35]
    v_mul_lo_u32 v16, v3, s48
    v_add_u32 v8, v8, v16
    v_mul_f32 v30, s51, v28
    v_cndmask_b32 v16, v68, v70, vcc
    v_cndmask_b32 v17, v69, v71, vcc
    v_mul_f32 v16, v30, v16
    v_mul_f32 v17, v30, v17
    v_cvt_pk_bf16_f32 v36, v16, v17
    v_mov_b32 v37, 0x3f80
    v_mul_f32 v30, s51, v29
    v_cndmask_b32 v16, v84, v86, vcc
    v_cndmask_b32 v17, v85, v87, vcc
    v_mul_f32 v16, v30, v16
    v_mul_f32 v17, v30, v17
    v_cvt_pk_bf16_f32 v38, v16, v17
    v_mov_b32 v39, 0x3f80
    s_cbranch_scc1 k1_qkv_kernel_e01v
    buffer_store_dword v36, v8, s[20:23], s6 offen
    buffer_store_dword v38, v8, s[20:23], s7 offen
    s_branch k1_qkv_kernel_e01d
k1_qkv_kernel_e01v:
    buffer_store_dwordx2 v[36:37], v8, s[20:23], s6 offen
    buffer_store_dwordx2 v[38:39], v8, s[20:23], s7 offen
k1_qkv_kernel_e01d:
    s_cmp_eq_u32 s55, 2
    s_cselect_b64 s[34:35], -1, 0
    v_cndmask_b32 v8, v6, v7, s[34:35]
    v_mul_lo_u32 v16, v3, s49
    v_add_u32 v8, v8, v16
    v_mul_f32 v30, s52, v28
    v_cndmask_b32 v16, v72, v74, vcc
    v_cndmask_b32 v17, v73, v75, vcc
    v_mul_f32 v16, v30, v16
    v_mul_f32 v17, v30, v17
    v_cvt_pk_bf16_f32 v40, v16, v17
    v_mov_b32 v41, 0x3f80
    v_mul_f32 v30, s52, v29
    v_cndmask_b32 v16, v88, v90, vcc
    v_cndmask_b32 v17, v89, v91, vcc
    v_mul_f32 v16, v30, v16
    v_mul_f32 v17, v30, v17
    v_cvt_pk_bf16_f32 v42, v16, v17
    v_mov_b32 v43, 0x3f80
    s_cbranch_scc1 k1_qkv_kernel_e02v
    buffer_store_dword v40, v8, s[20:23], s8 offen
    buffer_store_dword v42, v8, s[20:23], s9 offen
    s_branch k1_qkv_kernel_e02d
k1_qkv_kernel_e02v:
    buffer_store_dwordx2 v[40:41], v8, s[20:23], s8 offen
    buffer_store_dwordx2 v[42:43], v8, s[20:23], s9 offen
k1_qkv_kernel_e02d:
k1_qkv_kernel_done0:
    v_pk_fma_f32 v[96:97], v[144:145], v[24:25], v[96:97] op_sel_hi:[1,0,1] neg_lo:[0,1,0] neg_hi:[0,1,0]
    v_pk_fma_f32 v[98:99], v[146:147], v[24:25], v[98:99] op_sel_hi:[1,0,1] neg_lo:[0,1,0] neg_hi:[0,1,0]
    v_pk_fma_f32 v[100:101], v[148:149], v[24:25], v[100:101] op_sel_hi:[1,0,1] neg_lo:[0,1,0] neg_hi:[0,1,0]
    v_pk_fma_f32 v[102:103], v[150:151], v[24:25], v[102:103] op_sel_hi:[1,0,1] neg_lo:[0,1,0] neg_hi:[0,1,0]
    v_pk_fma_f32 v[104:105], v[152:153], v[24:25], v[104:105] op_sel_hi:[1,0,1] neg_lo:[0,1,0] neg_hi:[0,1,0]
    v_pk_fma_f32 v[106:107], v[154:155], v[24:25], v[106:107] op_sel_hi:[1,0,1] neg_lo:[0,1,0] neg_hi:[0,1,0]
    v_pk_fma_f32 v[108:109], v[156:157], v[24:25], v[108:109] op_sel_hi:[1,0,1] neg_lo:[0,1,0] neg_hi:[0,1,0]
    v_pk_fma_f32 v[110:111], v[158:159], v[24:25], v[110:111] op_sel_hi:[1,0,1] neg_lo:[0,1,0] neg_hi:[0,1,0]
    v_pk_fma_f32 v[112:113], v[144:145], v[26:27], v[112:113] op_sel_hi:[1,0,1] neg_lo:[0,1,0] neg_hi:[0,1,0]
    v_pk_fma_f32 v[114:115], v[146:147], v[26:27], v[114:115] op_sel_hi:[1,0,1] neg_lo:[0,1,0] neg_hi:[0,1,0]
    v_pk_fma_f32 v[116:117], v[148:149], v[26:27], v[116:117] op_sel_hi:[1,0,1] neg_lo:[0,1,0] neg_hi:[0,1,0]
    v_pk_fma_f32 v[118:119], v[150:151], v[26:27], v[118:119] op_sel_hi:[1,0,1] neg_lo:[0,1,0] neg_hi:[0,1,0]
    v_pk_fma_f32 v[120:121], v[152:153], v[26:27], v[120:121] op_sel_hi:[1,0,1] neg_lo:[0,1,0] neg_hi:[0,1,0]
    v_pk_fma_f32 v[122:123], v[154:155], v[26:27], v[122:123] op_sel_hi:[1,0,1] neg_lo:[0,1,0] neg_hi:[0,1,0]
    v_pk_fma_f32 v[124:125], v[156:157], v[26:27], v[124:125] op_sel_hi:[1,0,1] neg_lo:[0,1,0] neg_hi:[0,1,0]
    v_pk_fma_f32 v[126:127], v[158:159], v[26:27], v[126:127] op_sel_hi:[1,0,1] neg_lo:[0,1,0] neg_hi:[0,1,0]
    s_cmp_eq_u32 s101, 3
    s_cbranch_scc1 k1_qkv_kernel_ext1
    s_cmp_eq_u32 s101, 2
    s_cselect_b64 s[34:35], -1, 0
    v_cndmask_b32 v8, v4, v5, s[34:35]
    v_mul_f32 v30, s99, v28
    s_add_u32 s42, s68, s71
    v_pk_mul_f32 v[96:97], v[96:97], v[30:31] op_sel_hi:[1,0]
    v_pk_mul_f32 v[98:99], v[98:99], v[30:31] op_sel_hi:[1,0]
    v_pk_mul_f32 v[100:101], v[100:101], v[30:31] op_sel_hi:[1,0]
    v_pk_mul_f32 v[102:103], v[102:103], v[30:31] op_sel_hi:[1,0]
    v_pk_mul_f32 v[104:105], v[104:105], v[30:31] op_sel_hi:[1,0]
    v_pk_mul_f32 v[106:107], v[106:107], v[30:31] op_sel_hi:[1,0]
    v_pk_mul_f32 v[108:109], v[108:109], v[30:31] op_sel_hi:[1,0]
    v_pk_mul_f32 v[110:111], v[110:111], v[30:31] op_sel_hi:[1,0]
    v_cvt_pk_bf16_f32 v188, v96, v97
    v_cvt_pk_bf16_f32 v189, v98, v99
    v_cvt_pk_bf16_f32 v190, v100, v101
    v_cvt_pk_bf16_f32 v191, v102, v103
    v_cvt_pk_bf16_f32 v192, v104, v105
    v_cvt_pk_bf16_f32 v193, v106, v107
    v_cvt_pk_bf16_f32 v194, v108, v109
    v_cvt_pk_bf16_f32 v195, v110, v111
    buffer_store_dwordx4 v[188:191], v8, s[20:23], s68 offen
    buffer_store_dwordx4 v[192:195], v8, s[20:23], s42 offen
    v_mul_f32 v30, s99, v29
    s_add_u32 s42, s69, s71
    v_pk_mul_f32 v[112:113], v[112:113], v[30:31] op_sel_hi:[1,0]
    v_pk_mul_f32 v[114:115], v[114:115], v[30:31] op_sel_hi:[1,0]
    v_pk_mul_f32 v[116:117], v[116:117], v[30:31] op_sel_hi:[1,0]
    v_pk_mul_f32 v[118:119], v[118:119], v[30:31] op_sel_hi:[1,0]
    v_pk_mul_f32 v[120:121], v[120:121], v[30:31] op_sel_hi:[1,0]
    v_pk_mul_f32 v[122:123], v[122:123], v[30:31] op_sel_hi:[1,0]
    v_pk_mul_f32 v[124:125], v[124:125], v[30:31] op_sel_hi:[1,0]
    v_pk_mul_f32 v[126:127], v[126:127], v[30:31] op_sel_hi:[1,0]
    v_cvt_pk_bf16_f32 v196, v112, v113
    v_cvt_pk_bf16_f32 v197, v114, v115
    v_cvt_pk_bf16_f32 v198, v116, v117
    v_cvt_pk_bf16_f32 v199, v118, v119
    v_cvt_pk_bf16_f32 v200, v120, v121
    v_cvt_pk_bf16_f32 v201, v122, v123
    v_cvt_pk_bf16_f32 v202, v124, v125
    v_cvt_pk_bf16_f32 v203, v126, v127
    buffer_store_dwordx4 v[196:199], v8, s[20:23], s69 offen
    buffer_store_dwordx4 v[200:203], v8, s[20:23], s42 offen
    s_branch k1_qkv_kernel_done1
k1_qkv_kernel_ext1:
    v_cmp_eq_u32 vcc, 1, v3
    s_cmp_eq_u32 s53, 2
    s_cselect_b64 s[34:35], -1, 0
    v_cndmask_b32 v8, v6, v7, s[34:35]
    v_mul_lo_u32 v16, v3, s47
    v_add_u32 v8, v8, v16
    v_mul_f32 v30, s50, v28
    v_cndmask_b32 v16, v96, v98, vcc
    v_cndmask_b32 v17, v97, v99, vcc
    v_mul_f32 v16, v30, v16
    v_mul_f32 v17, v30, v17
    v_cvt_pk_bf16_f32 v32, v16, v17
    v_mov_b32 v33, 0x3f80
    v_mul_f32 v30, s50, v29
    v_cndmask_b32 v16, v112, v114, vcc
    v_cndmask_b32 v17, v113, v115, vcc
    v_mul_f32 v16, v30, v16
    v_mul_f32 v17, v30, v17
    v_cvt_pk_bf16_f32 v34, v16, v17
    v_mov_b32 v35, 0x3f80
    s_cbranch_scc1 k1_qkv_kernel_e10v
    buffer_store_dword v32, v8, s[20:23], s4 offen
    buffer_store_dword v34, v8, s[20:23], s5 offen
    s_branch k1_qkv_kernel_e10d
k1_qkv_kernel_e10v:
    buffer_store_dwordx2 v[32:33], v8, s[20:23], s4 offen
    buffer_store_dwordx2 v[34:35], v8, s[20:23], s5 offen
k1_qkv_kernel_e10d:
    s_cmp_eq_u32 s54, 2
    s_cselect_b64 s[34:35], -1, 0
    v_cndmask_b32 v8, v6, v7, s[34:35]
    v_mul_lo_u32 v16, v3, s48
    v_add_u32 v8, v8, v16
    v_mul_f32 v30, s51, v28
    v_cndmask_b32 v16, v100, v102, vcc
    v_cndmask_b32 v17, v101, v103, vcc
    v_mul_f32 v16, v30, v16
    v_mul_f32 v17, v30, v17
    v_cvt_pk_bf16_f32 v36, v16, v17
    v_mov_b32 v37, 0x3f80
    v_mul_f32 v30, s51, v29
    v_cndmask_b32 v16, v116, v118, vcc
    v_cndmask_b32 v17, v117, v119, vcc
    v_mul_f32 v16, v30, v16
    v_mul_f32 v17, v30, v17
    v_cvt_pk_bf16_f32 v38, v16, v17
    v_mov_b32 v39, 0x3f80
    s_cbranch_scc1 k1_qkv_kernel_e11v
    buffer_store_dword v36, v8, s[20:23], s6 offen
    buffer_store_dword v38, v8, s[20:23], s7 offen
    s_branch k1_qkv_kernel_e11d
k1_qkv_kernel_e11v:
    buffer_store_dwordx2 v[36:37], v8, s[20:23], s6 offen
    buffer_store_dwordx2 v[38:39], v8, s[20:23], s7 offen
k1_qkv_kernel_e11d:
    s_cmp_eq_u32 s55, 2
    s_cselect_b64 s[34:35], -1, 0
    v_cndmask_b32 v8, v6, v7, s[34:35]
    v_mul_lo_u32 v16, v3, s49
    v_add_u32 v8, v8, v16
    v_mul_f32 v30, s52, v28
    v_cndmask_b32 v16, v104, v106, vcc
    v_cndmask_b32 v17, v105, v107, vcc
    v_mul_f32 v16, v30, v16
    v_mul_f32 v17, v30, v17
    v_cvt_pk_bf16_f32 v40, v16, v17
    v_mov_b32 v41, 0x3f80
    v_mul_f32 v30, s52, v29
    v_cndmask_b32 v16, v120, v122, vcc
    v_cndmask_b32 v17, v121, v123, vcc
    v_mul_f32 v16, v30, v16
    v_mul_f32 v17, v30, v17
    v_cvt_pk_bf16_f32 v42, v16, v17
    v_mov_b32 v43, 0x3f80
    s_cbranch_scc1 k1_qkv_kernel_e12v
    buffer_store_dword v40, v8, s[20:23], s8 offen
    buffer_store_dword v42, v8, s[20:23], s9 offen
    s_branch k1_qkv_kernel_e12d
k1_qkv_kernel_e12v:
    buffer_store_dwordx2 v[40:41], v8, s[20:23], s8 offen
    buffer_store_dwordx2 v[42:43], v8, s[20:23], s9 offen
k1_qkv_kernel_e12d:
k1_qkv_kernel_done1:
    s_endpgm
.p2align 8
.globl k2_attn_kernel
.type k2_attn_kernel,@function
k2_attn_kernel:
    s_cmp_ge_u32 s2, 256
    s_cbranch_scc1 k2_attn_kernel_end
    s_load_dwordx2 s[8:9], s[0:1], 80
    s_load_dwordx2 s[4:5], s[0:1], 0
    s_load_dwordx2 s[6:7], s[0:1], 16
    s_load_dwordx4 s[56:59], s[0:1], 40
    s_load_dwordx2 s[60:61], s[0:1], 56
    s_load_dwordx2 s[66:67], s[0:1], 32
    s_load_dwordx2 s[64:65], s[0:1], 64
    s_and_b32 s10, s2, 7
    s_lshr_b32 s11, s2, 3
    s_lshl_b32 s20, s10, 2
    s_lshr_b32 s23, s11, 3
    s_add_u32 s20, s20, s23
    s_and_b32 s21, s11, 7
    v_and_b32 v1, 63, v0
    v_lshrrev_b32 v8, 6, v0
    v_and_b32 v2, 31, v0
    v_readfirstlane_b32 s22, v8
    v_bfe_u32 v3, v0, 5, 1
    v_lshlrev_b32 v7, 4, v1
    v_mov_b32 v5, 0
    s_and_b32 s28, s22, 3
    s_lshr_b32 s29, s22, 2
    s_mul_i32 s25, s20, 155648
    s_add_u32 s25, s25, 0
    s_mov_b32 s26, 0
    s_waitcnt lgkmcnt(0)
    s_mov_b32 s12, s8
    s_mov_b32 s13, s9
    s_mov_b32 s14, 17825792
    s_mov_b32 s15, 0x00020000
    s_mov_b32 s36, s4
    s_mov_b32 s37, s5
    s_mov_b32 s38, 2359296
    s_mov_b32 s39, 0x00020000
    s_mov_b32 s40, s6
    s_mov_b32 s41, s7
    s_mov_b32 s42, 663552
    s_mov_b32 s43, 0x00020000
    s_mov_b32 s44, s56
    s_mov_b32 s45, s57
    s_mov_b32 s46, 5308416
    s_mov_b32 s47, 0x00020000
    s_mov_b32 s48, s58
    s_mov_b32 s49, s59
    s_mov_b32 s50, 5308416
    s_mov_b32 s51, 0x00020000
    s_mov_b32 s52, s60
    s_mov_b32 s53, s61
    s_mov_b32 s54, 5308416
    s_mov_b32 s55, 0x00020000
    s_mov_b32 s68, s66
    s_mov_b32 s69, s67
    s_mov_b32 s70, 1152
    s_mov_b32 s71, 0x00020000
    s_mov_b32 s16, s64
    s_mov_b32 s17, s65
    s_mov_b32 s18, 2359296
    s_mov_b32 s19, 0x00020000
k2_attn_kernel_start:
    s_cmp_ge_u32 s22, 8
    s_cbranch_scc1 k2_attn_kernel_loader
    s_lshl_b32 s23, s21, 3
    s_lshl_b32 s24, s28, 1
    s_add_u32 s23, s23, s24
    s_mul_i32 s24, s20, 73728
    s_add_u32 s24, s24, 5242880
    s_lshl_b32 s27, s23, 10
    s_add_u32 s27, s27, s24
    buffer_load_dwordx4 v[16:19], v7, s[12:15], s27 offen
    buffer_load_dwordx4 v[20:23], v7, s[12:15], s27 offen offset:1024
    s_lshl_b32 s27, s23, 7
    s_add_u32 s27, s27, s24
    s_add_u32 s27, s27, 65536
    v_lshlrev_b32 v8, 2, v2
    buffer_load_dword v24, v8, s[12:15], s27 offen
    buffer_load_dword v26, v8, s[12:15], s27 offen offset:128
    s_lshl_b32 s23, s22, 10
    s_add_u32 s24, s25, s23
    s_mov_b32 s62, s23
    s_mov_b32 s63, s24
    s_add_u32 m0, s62, 0
    s_add_u32 s24, s63, 0
    buffer_load_dwordx4 v7, s[12:15], s24 offen lds
    s_add_u32 m0, s62, 8192
    s_add_u32 s24, s63, 8192
    buffer_load_dwordx4 v7, s[12:15], s24 offen lds
    s_add_u32 m0, s62, 16384
    s_add_u32 s24, s63, 16384
    buffer_load_dwordx4 v7, s[12:15], s24 offen lds
    v_and_b32 v8, 15, v1
    v_lshlrev_b32 v8, 2, v8
    v_add_u32 v8, 155648, v8
    v_mov_b32 v9, 0
    ds_write_b32 v8, v9
    v_mov_b32 v37, 0x3f803f80
    v_mov_b32 v39, 0x3f803f80
    v_mov_b32 v25, 0
    v_mov_b32 v27, 0
    v_bfe_u32 v8, v1, 2, 2
    v_mul_u32_u24 v6, 192, v3
    v_lshl_add_u32 v6, v8, 5, v6
    v_and_b32 v9, 3, v1
    v_lshl_add_u32 v6, v9, 3, v6
    v_lshl_add_u32 v8, v3, 2, v8
    v_lshlrev_b32 v8, 3, v8
    v_add_u32 v8, 128, v8
    v_and_b32 v9, 16, v1
    v_cmp_ne_u32 vcc, 0, v9
    s_nop 1
    v_cndmask_b32 v6, v6, v8, vcc
    s_mul_i32 s23, s29, 5120
    s_add_u32 s23, s23, 9216
    v_add_u32 v6, s23, v6
    v_mov_b32 v96, 0
    v_mov_b32 v112, 0
    v_mov_b32 v97, 0
    v_mov_b32 v113, 0
    v_mov_b32 v98, 0
    v_mov_b32 v114, 0
    v_mov_b32 v99, 0
    v_mov_b32 v115, 0
    v_mov_b32 v100, 0
    v_mov_b32 v116, 0
    v_mov_b32 v101, 0
    v_mov_b32 v117, 0
    v_mov_b32 v102, 0
    v_mov_b32 v118, 0
    v_mov_b32 v103, 0
    v_mov_b32 v119, 0
    v_mov_b32 v104, 0
    v_mov_b32 v120, 0
    v_mov_b32 v105, 0
    v_mov_b32 v121, 0
    v_mov_b32 v106, 0
    v_mov_b32 v122, 0
    v_mov_b32 v107, 0
    v_mov_b32 v123, 0
    v_mov_b32 v108, 0
    v_mov_b32 v124, 0
    v_mov_b32 v109, 0
    v_mov_b32 v125, 0
    v_mov_b32 v110, 0
    v_mov_b32 v126, 0
    v_mov_b32 v111, 0
    v_mov_b32 v127, 0
    v_mov_b32 v56, 0
    v_mov_b32 v57, 0
    v_mov_b32 v58, 0
    v_mov_b32 v59, 0
    v_mov_b32 v60, 0
    v_mov_b32 v61, 0
    v_mov_b32 v62, 0
    v_mov_b32 v63, 0
    v_mov_b32 v52, 0
    v_mov_b32 v53, 0
    v_mov_b32 v54, 0
    v_mov_b32 v55, 0
    s_waitcnt vmcnt(0) lgkmcnt(0)
    s_barrier
    v_cmp_eq_u32 vcc, 0, v3
    s_nop 1
    v_cndmask_b32 v24, 0, v24, vcc
    v_cndmask_b32 v26, 0, v26, vcc
    s_cmp_eq_u32 s26, 0
    s_cselect_b32 s30, 1, 64
    s_mov_b32 s27, 0
    v_mov_b32 v12, 0xff800000
    v_mov_b32 v13, 0xff800000
k2_attn_kernel_mx:
    s_lshr_b32 s23, s27, 3
    s_mul_i32 s23, s23, 19456
    s_and_b32 s24, s27, 7
    s_lshl_b32 s24, s24, 10
    s_add_u32 s24, s24, s23
    v_add_u32 v8, s24, v7
    ds_read_b128 v[28:31], v8
    s_and_b32 s24, s27, 7
    s_lshl_b32 s24, s24, 7
    s_add_u32 s24, s24, s23
    v_lshl_add_u32 v8, v2, 2, s24
    ds_read_b32 v36, v8 offset:8192
    s_waitcnt lgkmcnt(0)
    v_mfma_f32_32x32x16_bf16 v[64:79], v[28:31], v[16:19], 0
    v_mfma_f32_32x32x8_bf16 v[64:79], v[36:37], v[24:25], v[64:79]
    v_mfma_f32_32x32x16_bf16 v[80:95], v[28:31], v[20:23], 0
    v_mfma_f32_32x32x8_bf16 v[80:95], v[36:37], v[26:27], v[80:95]
    s_nop 9
    v_max3_f32 v12, v64, v65, v12
    v_max3_f32 v12, v66, v67, v12
    v_max3_f32 v12, v68, v69, v12
    v_max3_f32 v12, v70, v71, v12
    v_max3_f32 v12, v72, v73, v12
    v_max3_f32 v12, v74, v75, v12
    v_max3_f32 v12, v76, v77, v12
    v_max3_f32 v12, v78, v79, v12
    v_max3_f32 v13, v80, v81, v13
    v_max3_f32 v13, v82, v83, v13
    v_max3_f32 v13, v84, v85, v13
    v_max3_f32 v13, v86, v87, v13
    v_max3_f32 v13, v88, v89, v13
    v_max3_f32 v13, v90, v91, v13
    v_max3_f32 v13, v92, v93, v13
    v_max3_f32 v13, v94, v95, v13
    s_add_u32 s27, s27, 1
    s_cmp_lt_u32 s27, s30
    s_cbranch_scc1 k2_attn_kernel_mx
    v_cmp_eq_u32 vcc, 0, v3
    v_mov_b32 v8, v12
    s_nop 1
    v_permlane32_swap_b32 v12, v8
    v_max_f32 v8, v12, v8
    v_xor_b32 v8, 0x80000000, v8
    v_and_b32 v9, 0xffff0000, v8
    v_sub_f32 v8, v8, v9
    v_and_b32 v10, 0xffff0000, v8
    v_sub_f32 v8, v8, v10
    v_lshrrev_b32 v9, 16, v9
    v_or_b32 v9, v9, v10
    v_lshrrev_b32 v8, 16, v8
    v_cndmask_b32 v25, v8, v9, vcc
    v_mov_b32 v8, v13
    s_nop 1
    v_permlane32_swap_b32 v13, v8
    v_max_f32 v8, v13, v8
    v_xor_b32 v8, 0x80000000, v8
    v_and_b32 v9, 0xffff0000, v8
    v_sub_f32 v8, v8, v9
    v_and_b32 v10, 0xffff0000, v8
    v_sub_f32 v8, v8, v10
    v_lshrrev_b32 v9, 16, v9
    v_or_b32 v9, v9, v10
    v_lshrrev_b32 v8, 16, v8
    v_cndmask_b32 v27, v8, v9, vcc
    s_lshl_b32 s23, s29, 12
    v_add_u32 v4, s23, v7
    s_lshl_b32 s23, s29, 9
    s_add_u32 s23, s23, 8192
    v_lshl_add_u32 v5, v2, 2, s23
    ds_read_b128 v[28:31], v4 offset:0
    ds_read_b32 v36, v5 offset:0
    ds_read_b128 v[32:35], v4 offset:1024
    ds_read_b32 v38, v5 offset:128
    ds_read_b64_tr_b16 v[40:41], v6 offset:0
    ds_read_b64_tr_b16 v[42:43], v6 offset:320
    ds_read_b64_tr_b16 v[44:45], v6 offset:640
    ds_read_b64_tr_b16 v[46:47], v6 offset:960
    s_waitcnt lgkmcnt(6)
    v_mfma_f32_32x32x16_bf16 v[64:79], v[28:31], v[16:19], 0
    v_mfma_f32_32x32x8_bf16 v[64:79], v[36:37], v[24:25], v[64:79]
    s_mov_b32 s27, 0
    s_mov_b32 s31, 0x07060302
    s_nop 7
    s_nop 3
k2_attn_kernel_loop:
    v_mfma_f32_32x32x16_bf16 v[80:95], v[28:31], v[20:23], 0
    v_exp_f32 v64, v64
    v_exp_f32 v65, v65
    v_exp_f32 v66, v66
    v_exp_f32 v67, v67
    v_cvt_pk_bf16_f32 v56, v64, v65
    v_cvt_pk_bf16_f32 v57, v66, v67
    v_mfma_f32_32x32x8_bf16 v[80:95], v[36:37], v[26:27], v[80:95]
    ds_read_b128 v[28:31], v4 offset:2048
    ds_read_b32 v36, v5 offset:256
    v_exp_f32 v68, v68
    v_exp_f32 v69, v69
    v_exp_f32 v70, v70
    v_exp_f32 v71, v71
    v_cvt_pk_bf16_f32 v58, v68, v69
    v_cvt_pk_bf16_f32 v59, v70, v71
    v_mfma_f32_32x32x16_bf16 v[112:127], v[52:55], v[60:63], v[112:127]
    ds_read_b64_tr_b16 v[48:49], v6 offset:1280
    ds_read_b64_tr_b16 v[50:51], v6 offset:1600
    ds_read_b64_tr_b16 v[52:53], v6 offset:1920
    ds_read_b64_tr_b16 v[54:55], v6 offset:2240
    v_exp_f32 v72, v72
    v_exp_f32 v73, v73
    v_exp_f32 v74, v74
    v_exp_f32 v75, v75
    v_cvt_pk_bf16_f32 v60, v72, v73
    v_cvt_pk_bf16_f32 v61, v74, v75
    s_waitcnt lgkmcnt(6)
    v_mfma_f32_32x32x16_bf16 v[96:111], v[40:43], v[56:59], v[96:111]
    v_exp_f32 v76, v76
    v_exp_f32 v77, v77
    v_exp_f32 v78, v78
    v_exp_f32 v79, v79
    v_cvt_pk_bf16_f32 v62, v76, v77
    v_cvt_pk_bf16_f32 v63, v78, v79
    v_mfma_f32_32x32x16_bf16 v[64:79], v[32:35], v[16:19], 0
    v_exp_f32 v80, v80
    v_exp_f32 v81, v81
    v_exp_f32 v82, v82
    v_exp_f32 v83, v83
    v_cvt_pk_bf16_f32 v56, v80, v81
    v_cvt_pk_bf16_f32 v57, v82, v83
    v_mfma_f32_32x32x8_bf16 v[64:79], v[38:39], v[24:25], v[64:79]
    v_exp_f32 v84, v84
    v_exp_f32 v85, v85
    v_exp_f32 v86, v86
    v_exp_f32 v87, v87
    v_cvt_pk_bf16_f32 v58, v84, v85
    v_cvt_pk_bf16_f32 v59, v86, v87
    v_mfma_f32_32x32x16_bf16 v[96:111], v[44:47], v[60:63], v[96:111]
    v_exp_f32 v88, v88
    v_exp_f32 v89, v89
    v_exp_f32 v90, v90
    v_exp_f32 v91, v91
    v_cvt_pk_bf16_f32 v60, v88, v89
    v_cvt_pk_bf16_f32 v61, v90, v91
    v_mfma_f32_32x32x16_bf16 v[112:127], v[40:43], v[56:59], v[112:127]
    v_exp_f32 v92, v92
    v_exp_f32 v93, v93
    v_exp_f32 v94, v94
    v_exp_f32 v95, v95
    v_cvt_pk_bf16_f32 v62, v92, v93
    v_cvt_pk_bf16_f32 v63, v94, v95
    v_mfma_f32_32x32x16_bf16 v[80:95], v[32:35], v[20:23], 0
    v_exp_f32 v64, v64
    v_exp_f32 v65, v65
    v_exp_f32 v66, v66
    v_exp_f32 v67, v67
    v_cvt_pk_bf16_f32 v56, v64, v65
    v_cvt_pk_bf16_f32 v57, v66, v67
    v_mfma_f32_32x32x8_bf16 v[80:95], v[38:39], v[26:27], v[80:95]
    ds_read_b128 v[32:35], v4 offset:3072
    ds_read_b32 v38, v5 offset:384
    v_exp_f32 v68, v68
    v_exp_f32 v69, v69
    v_exp_f32 v70, v70
    v_exp_f32 v71, v71
    v_cvt_pk_bf16_f32 v58, v68, v69
    v_cvt_pk_bf16_f32 v59, v70, v71
    v_mfma_f32_32x32x16_bf16 v[112:127], v[44:47], v[60:63], v[112:127]
    ds_read_b64_tr_b16 v[40:41], v6 offset:2560
    ds_read_b64_tr_b16 v[42:43], v6 offset:2880
    ds_read_b64_tr_b16 v[44:45], v6 offset:3200
    ds_read_b64_tr_b16 v[46:47], v6 offset:3520
    v_exp_f32 v72, v72
    v_exp_f32 v73, v73
    v_exp_f32 v74, v74
    v_exp_f32 v75, v75
    v_cvt_pk_bf16_f32 v60, v72, v73
    v_cvt_pk_bf16_f32 v61, v74, v75
    s_waitcnt lgkmcnt(6)
    v_mfma_f32_32x32x16_bf16 v[96:111], v[48:51], v[56:59], v[96:111]
    v_exp_f32 v76, v76
    v_exp_f32 v77, v77
    v_exp_f32 v78, v78
    v_exp_f32 v79, v79
    v_cvt_pk_bf16_f32 v62, v76, v77
    v_cvt_pk_bf16_f32 v63, v78, v79
    v_mfma_f32_32x32x16_bf16 v[64:79], v[28:31], v[16:19], 0
    v_exp_f32 v80, v80
    v_exp_f32 v81, v81
    v_exp_f32 v82, v82
    v_exp_f32 v83, v83
    v_cvt_pk_bf16_f32 v56, v80, v81
    v_cvt_pk_bf16_f32 v57, v82, v83
    v_mfma_f32_32x32x8_bf16 v[64:79], v[36:37], v[24:25], v[64:79]
    v_exp_f32 v84, v84
    v_exp_f32 v85, v85
    v_exp_f32 v86, v86
    v_exp_f32 v87, v87
    v_cvt_pk_bf16_f32 v58, v84, v85
    v_cvt_pk_bf16_f32 v59, v86, v87
    v_mfma_f32_32x32x16_bf16 v[96:111], v[52:55], v[60:63], v[96:111]
    v_exp_f32 v88, v88
    v_exp_f32 v89, v89
    v_exp_f32 v90, v90
    v_exp_f32 v91, v91
    v_cvt_pk_bf16_f32 v60, v88, v89
    v_cvt_pk_bf16_f32 v61, v90, v91
    v_mfma_f32_32x32x16_bf16 v[112:127], v[48:51], v[56:59], v[112:127]
    v_exp_f32 v92, v92
    v_exp_f32 v93, v93
    v_exp_f32 v94, v94
    v_exp_f32 v95, v95
    v_cvt_pk_bf16_f32 v62, v92, v93
    v_cvt_pk_bf16_f32 v63, v94, v95
    s_lshl_b32 s23, 1, s27
    s_and_b32 s23, s23, 0x43
    s_cbranch_scc0 k2_attn_kernel_nb
    s_barrier
k2_attn_kernel_nb:
    v_mfma_f32_32x32x16_bf16 v[80:95], v[28:31], v[20:23], 0
    v_exp_f32 v64, v64
    v_exp_f32 v65, v65
    v_exp_f32 v66, v66
    v_exp_f32 v67, v67
    v_cvt_pk_bf16_f32 v56, v64, v65
    v_cvt_pk_bf16_f32 v57, v66, v67
    v_mfma_f32_32x32x8_bf16 v[80:95], v[36:37], v[26:27], v[80:95]
    ds_read_b128 v[28:31], v4 offset:19456
    ds_read_b32 v36, v5 offset:19456
    v_exp_f32 v68, v68
    v_exp_f32 v69, v69
    v_exp_f32 v70, v70
    v_exp_f32 v71, v71
    v_cvt_pk_bf16_f32 v58, v68, v69
    v_cvt_pk_bf16_f32 v59, v70, v71
    v_mfma_f32_32x32x16_bf16 v[112:127], v[52:55], v[60:63], v[112:127]
    ds_read_b64_tr_b16 v[48:49], v6 offset:3840
    ds_read_b64_tr_b16 v[50:51], v6 offset:4160
    ds_read_b64_tr_b16 v[52:53], v6 offset:4480
    ds_read_b64_tr_b16 v[54:55], v6 offset:4800
    v_exp_f32 v72, v72
    v_exp_f32 v73, v73
    v_exp_f32 v74, v74
    v_exp_f32 v75, v75
    v_cvt_pk_bf16_f32 v60, v72, v73
    v_cvt_pk_bf16_f32 v61, v74, v75
    s_waitcnt lgkmcnt(6)
    v_mfma_f32_32x32x16_bf16 v[96:111], v[40:43], v[56:59], v[96:111]
    v_exp_f32 v76, v76
    v_exp_f32 v77, v77
    v_exp_f32 v78, v78
    v_exp_f32 v79, v79
    v_cvt_pk_bf16_f32 v62, v76, v77
    v_cvt_pk_bf16_f32 v63, v78, v79
    v_mfma_f32_32x32x16_bf16 v[64:79], v[32:35], v[16:19], 0
    v_exp_f32 v80, v80
    v_exp_f32 v81, v81
    v_exp_f32 v82, v82
    v_exp_f32 v83, v83
    v_cvt_pk_bf16_f32 v56, v80, v81
    v_cvt_pk_bf16_f32 v57, v82, v83
    v_mfma_f32_32x32x8_bf16 v[64:79], v[38:39], v[24:25], v[64:79]
    v_exp_f32 v84, v84
    v_exp_f32 v85, v85
    v_exp_f32 v86, v86
    v_exp_f32 v87, v87
    v_cvt_pk_bf16_f32 v58, v84, v85
    v_cvt_pk_bf16_f32 v59, v86, v87
    v_mfma_f32_32x32x16_bf16 v[96:111], v[44:47], v[60:63], v[96:111]
    v_exp_f32 v88, v88
    v_exp_f32 v89, v89
    v_exp_f32 v90, v90
    v_exp_f32 v91, v91
    v_cvt_pk_bf16_f32 v60, v88, v89
    v_cvt_pk_bf16_f32 v61, v90, v91
    v_mfma_f32_32x32x16_bf16 v[112:127], v[40:43], v[56:59], v[112:127]
    v_exp_f32 v92, v92
    v_exp_f32 v93, v93
    v_exp_f32 v94, v94
    v_exp_f32 v95, v95
    v_cvt_pk_bf16_f32 v62, v92, v93
    v_cvt_pk_bf16_f32 v63, v94, v95
    v_mfma_f32_32x32x16_bf16 v[80:95], v[32:35], v[20:23], 0
    v_exp_f32 v64, v64
    v_exp_f32 v65, v65
    v_exp_f32 v66, v66
    v_exp_f32 v67, v67
    v_cvt_pk_bf16_f32 v56, v64, v65
    v_cvt_pk_bf16_f32 v57, v66, v67
    v_mfma_f32_32x32x8_bf16 v[80:95], v[38:39], v[26:27], v[80:95]
    ds_read_b128 v[32:35], v4 offset:20480
    ds_read_b32 v38, v5 offset:19584
    v_exp_f32 v68, v68
    v_exp_f32 v69, v69
    v_exp_f32 v70, v70
    v_exp_f32 v71, v71
    v_cvt_pk_bf16_f32 v58, v68, v69
    v_cvt_pk_bf16_f32 v59, v70, v71
    v_mfma_f32_32x32x16_bf16 v[112:127], v[44:47], v[60:63], v[112:127]
    ds_read_b64_tr_b16 v[40:41], v6 offset:19456
    ds_read_b64_tr_b16 v[42:43], v6 offset:19776
    ds_read_b64_tr_b16 v[44:45], v6 offset:20096
    ds_read_b64_tr_b16 v[46:47], v6 offset:20416
    v_exp_f32 v72, v72
    v_exp_f32 v73, v73
    v_exp_f32 v74, v74
    v_exp_f32 v75, v75
    v_cvt_pk_bf16_f32 v60, v72, v73
    v_cvt_pk_bf16_f32 v61, v74, v75
    s_waitcnt lgkmcnt(6)
    v_mfma_f32_32x32x16_bf16 v[96:111], v[48:51], v[56:59], v[96:111]
    v_exp_f32 v76, v76
    v_exp_f32 v77, v77
    v_exp_f32 v78, v78
    v_exp_f32 v79, v79
    v_cvt_pk_bf16_f32 v62, v76, v77
    v_cvt_pk_bf16_f32 v63, v78, v79
    v_mfma_f32_32x32x16_bf16 v[64:79], v[28:31], v[16:19], 0
    v_exp_f32 v80, v80
    v_exp_f32 v81, v81
    v_exp_f32 v82, v82
    v_exp_f32 v83, v83
    v_cvt_pk_bf16_f32 v56, v80, v81
    v_cvt_pk_bf16_f32 v57, v82, v83
    v_mfma_f32_32x32x8_bf16 v[64:79], v[36:37], v[24:25], v[64:79]
    v_exp_f32 v84, v84
    v_exp_f32 v85, v85
    v_exp_f32 v86, v86
    v_exp_f32 v87, v87
    v_cvt_pk_bf16_f32 v58, v84, v85
    v_cvt_pk_bf16_f32 v59, v86, v87
    v_mfma_f32_32x32x16_bf16 v[96:111], v[52:55], v[60:63], v[96:111]
    v_exp_f32 v88, v88
    v_exp_f32 v89, v89
    v_exp_f32 v90, v90
    v_exp_f32 v91, v91
    v_cvt_pk_bf16_f32 v60, v88, v89
    v_cvt_pk_bf16_f32 v61, v90, v91
    v_mfma_f32_32x32x16_bf16 v[112:127], v[48:51], v[56:59], v[112:127]
    v_exp_f32 v92, v92
    v_exp_f32 v93, v93
    v_exp_f32 v94, v94
    v_exp_f32 v95, v95
    v_cvt_pk_bf16_f32 v62, v92, v93
    v_cvt_pk_bf16_f32 v63, v94, v95
    v_add_u32 v4, 19456, v4
    v_add_u32 v5, 19456, v5
    v_add_u32 v6, 19456, v6
    s_add_u32 s27, s27, 1
    s_cmp_lt_u32 s27, 8
    s_cbranch_scc1 k2_attn_kernel_loop
    v_mfma_f32_32x32x16_bf16 v[112:127], v[52:55], v[60:63], v[112:127]
    s_waitcnt lgkmcnt(0)
    s_barrier
    s_cmp_eq_u32 s29, 1
    s_cselect_b64 s[32:33], -1, 0
    s_lshl_b32 s23, s28, 1
    s_add_u32 s23, s23, s29
    s_xor_b32 s24, s23, 1
    s_mul_i32 s23, s23, 3072
    s_mul_i32 s24, s24, 3072
    s_add_u32 s23, s23, 131072
    s_add_u32 s24, s24, 131072
    v_add_u32 v8, s24, v7
    v_add_u32 v9, s23, v7
    v_cndmask_b32 v64, v112, v96, s[32:33]
    v_cndmask_b32 v80, v96, v112, s[32:33]
    v_cndmask_b32 v65, v113, v97, s[32:33]
    v_cndmask_b32 v81, v97, v113, s[32:33]
    v_cndmask_b32 v66, v114, v98, s[32:33]
    v_cndmask_b32 v82, v98, v114, s[32:33]
    v_cndmask_b32 v67, v115, v99, s[32:33]
    v_cndmask_b32 v83, v99, v115, s[32:33]
    v_cndmask_b32 v68, v116, v100, s[32:33]
    v_cndmask_b32 v84, v100, v116, s[32:33]
    v_cndmask_b32 v69, v117, v101, s[32:33]
    v_cndmask_b32 v85, v101, v117, s[32:33]
    v_cndmask_b32 v70, v118, v102, s[32:33]
    v_cndmask_b32 v86, v102, v118, s[32:33]
    v_cndmask_b32 v71, v119, v103, s[32:33]
    v_cndmask_b32 v87, v103, v119, s[32:33]
    v_cndmask_b32 v72, v120, v104, s[32:33]
    v_cndmask_b32 v88, v104, v120, s[32:33]
    v_cndmask_b32 v73, v121, v105, s[32:33]
    v_cndmask_b32 v89, v105, v121, s[32:33]
    v_cndmask_b32 v74, v122, v106, s[32:33]
    v_cndmask_b32 v90, v106, v122, s[32:33]
    v_cndmask_b32 v75, v123, v107, s[32:33]
    v_cndmask_b32 v91, v107, v123, s[32:33]
    ds_write_b128 v8, v[64:67] offset:0
    ds_write_b128 v8, v[68:71] offset:1024
    ds_write_b128 v8, v[72:75] offset:2048
    s_waitcnt lgkmcnt(0)
    s_barrier
    ds_read_b128 v[64:67], v9 offset:0
    ds_read_b128 v[68:71], v9 offset:1024
    ds_read_b128 v[72:75], v9 offset:2048
    s_waitcnt lgkmcnt(0)
    v_add_f32 v80, v80, v64
    v_add_f32 v81, v81, v65
    v_add_f32 v82, v82, v66
    v_add_f32 v83, v83, v67
    v_add_f32 v84, v84, v68
    v_add_f32 v85, v85, v69
    v_add_f32 v86, v86, v70
    v_add_f32 v87, v87, v71
    v_add_f32 v88, v88, v72
    v_add_f32 v89, v89, v73
    v_add_f32 v90, v90, v74
    v_cmp_ngt_f32 vcc, 0x5d800000, v90
    v_mov_b32 v10, 0x12800000
    v_cmp_nlt_f32 s[32:33], v10, v90
    v_rcp_f32 v11, v90
    s_or_b64 vcc, vcc, s[32:33]
    s_cbranch_vccz k2_attn_kernel_ok
    v_mov_b32 v8, 155648
    v_mov_b32 v9, 1
    ds_write_b32 v8, v9
k2_attn_kernel_ok:
    v_mul_f32 v80, v11, v80
    v_mul_f32 v81, v11, v81
    v_mul_f32 v82, v11, v82
    v_mul_f32 v83, v11, v83
    v_mul_f32 v84, v11, v84
    v_mul_f32 v85, v11, v85
    v_mul_f32 v86, v11, v86
    v_mul_f32 v87, v11, v87
    v_mul_f32 v88, v11, v88
    v_mul_f32 v89, v11, v89
    v_cvt_pk_bf16_f32 v56, v80, v81
    v_cvt_pk_bf16_f32 v57, v82, v83
    v_cvt_pk_bf16_f32 v58, v84, v85
    v_cvt_pk_bf16_f32 v59, v86, v87
    v_cvt_pk_bf16_f32 v60, v88, v89
    s_lshl_b32 s23, s21, 3
    s_lshl_b32 s24, s28, 1
    s_add_u32 s23, s23, s24
    s_add_u32 s23, s23, s29
    s_mul_i32 s23, s23, 36864
    s_add_u32 s23, s23, 8388608
    s_lshl_b32 s24, s20, 10
    s_add_u32 s24, s24, s23
    buffer_store_dwordx4 v[56:59], v7, s[12:15], s24 offen sc1
    s_lshl_b32 s24, s20, 7
    s_add_u32 s23, s23, s24
    s_add_u32 s23, s23, 32768
    v_lshlrev_b32 v8, 2, v2
    s_mov_b64 exec, 0xffffffff
    buffer_store_dword v60, v8, s[12:15], s23 offen sc1
    s_mov_b64 exec, -1
k2_attn_kernel_tail:
    s_waitcnt vmcnt(0) lgkmcnt(0)
    s_barrier
    s_cmp_eq_u32 s26, 1
    s_cbranch_scc1 k2_attn_kernel_pub
    v_mov_b32 v8, 155648
    ds_read_b32 v9, v8
    s_waitcnt lgkmcnt(0)
    v_readfirstlane_b32 s23, v9
    s_nop 0
    s_cmp_eq_u32 s23, 0
    s_cbranch_scc1 k2_attn_kernel_pub
    s_mov_b32 s26, 1
    s_barrier
    s_branch k2_attn_kernel_start
k2_attn_kernel_pub:
    s_cmp_lg_u32 s22, 4
    s_cbranch_scc1 k2_attn_kernel_nopub
    s_lshl_b32 s23, s21, 7
    s_lshl_b32 s24, s20, 2
    s_add_u32 s23, s23, s24
    s_add_u32 s23, s23, 14704640
    v_mov_b32 v8, 0
    v_mov_b32 v9, 1
    s_mov_b64 exec, 1
    buffer_store_dword v9, v8, s[12:15], s23 offen sc1
    s_mov_b64 exec, -1
k2_attn_kernel_nopub:
    s_mov_b64 exec, -1
    s_cmp_ge_u32 s22, 4
    s_cbranch_scc1 k2_attn_kernel_aux
    s_cmp_ge_u32 s11, 24
    s_cbranch_scc1 k2_attn_kernel_end
    s_mul_i32 s35, s11, 43
    s_lshr_b32 s35, s35, 8
    s_mul_i32 s76, s35, 6
    s_sub_u32 s76, s11, s76
    s_lshl_b32 s75, s10, 2
    s_add_u32 s75, s75, s35
    s_and_b32 s77, s22, 1
    s_bfe_u32 s78, s22, 0x10001
    s_lshl_b32 s79, s75, 1
    s_add_u32 s79, s79, s77
    v_mul_u32_u24 v5, 1152, v2
    v_lshl_add_u32 v5, v3, 3, v5
    v_lshlrev_b32 v6, 3, v3
    s_mul_i32 s35, s76, 192
    s_mul_i32 s62, s78, 96
    s_add_u32 s35, s35, s62
    s_mul_i32 s62, s79, 36864
    s_add_u32 s62, s62, s35
    s_mov_b32 s34, s62
    s_mov_b32 s63, s35
    s_mov_b32 s23, 110592
    s_cmp_eq_u32 s77, 1
    s_cselect_b32 s23, 155712, s23
    s_mul_i32 s24, s78, 96
    s_add_u32 s23, s23, s24
    v_mul_u32_u24 v8, 192, v2
    v_add3_u32 v8, v8, v6, s23
    ds_read_b64 v[28:29], v8 offset:0
    ds_read_b64 v[30:31], v8 offset:16
    ds_read_b64 v[32:33], v8 offset:32
    ds_read_b64 v[34:35], v8 offset:48
    ds_read_b64 v[36:37], v8 offset:64
    ds_read_b64 v[38:39], v8 offset:80
    buffer_load_dwordx2 v[12:13], v6, s[68:71], s35 offen offset:0
    buffer_load_dwordx2 v[14:15], v6, s[68:71], s35 offen offset:16
    buffer_load_dwordx2 v[16:17], v6, s[68:71], s35 offen offset:32
    buffer_load_dwordx2 v[18:19], v6, s[68:71], s35 offen offset:48
    buffer_load_dwordx2 v[20:21], v6, s[68:71], s35 offen offset:64
    buffer_load_dwordx2 v[22:23], v6, s[68:71], s35 offen offset:80
    v_bfe_u32 v8, v1, 2, 2
    v_lshl_add_u32 v8, v3, 3, v8
    v_mul_u32_u24 v4, 192, v8
    v_bfe_u32 v8, v1, 4, 1
    v_lshl_add_u32 v4, v8, 5, v4
    v_and_b32 v8, 3, v1
    v_lshl_add_u32 v4, v8, 3, v4
    s_mul_i32 s23, s78, 55296
    v_add_u32 v4, s23, v4
    v_lshlrev_b32 v6, 9, v3
    v_lshl_add_u32 v6, v2, 2, v6
    s_mul_i32 s62, s79, 36864
    s_add_u32 s62, s62, 8388608
    s_mul_i32 s23, s78, 18432
    s_add_u32 s35, s62, s23
    s_add_u32 s62, s62, 32768
    s_cmp_eq_u32 s78, 1
    s_cselect_b64 s[32:33], -1, 0
    s_waitcnt lgkmcnt(0)
    v_lshlrev_b32 v8, 16, v28
    v_and_b32 v9, 0xffff0000, v28
    v_cndmask_b32 v48, v8, 0, s[32:33]
    v_cndmask_b32 v49, v9, 0, s[32:33]
    v_cndmask_b32 v72, 0, v8, s[32:33]
    v_cndmask_b32 v73, 0, v9, s[32:33]
    v_lshlrev_b32 v8, 16, v29
    v_and_b32 v9, 0xffff0000, v29
    v_cndmask_b32 v50, v8, 0, s[32:33]
    v_cndmask_b32 v51, v9, 0, s[32:33]
    v_cndmask_b32 v74, 0, v8, s[32:33]
    v_cndmask_b32 v75, 0, v9, s[32:33]
    v_lshlrev_b32 v8, 16, v30
    v_and_b32 v9, 0xffff0000, v30
    v_cndmask_b32 v52, v8, 0, s[32:33]
    v_cndmask_b32 v53, v9, 0, s[32:33]
    v_cndmask_b32 v76, 0, v8, s[32:33]
    v_cndmask_b32 v77, 0, v9, s[32:33]
    v_lshlrev_b32 v8, 16, v31
    v_and_b32 v9, 0xffff0000, v31
    v_cndmask_b32 v54, v8, 0, s[32:33]
    v_cndmask_b32 v55, v9, 0, s[32:33]
    v_cndmask_b32 v78, 0, v8, s[32:33]
    v_cndmask_b32 v79, 0, v9, s[32:33]
    v_lshlrev_b32 v8, 16, v32
    v_and_b32 v9, 0xffff0000, v32
    v_cndmask_b32 v56, v8, 0, s[32:33]
    v_cndmask_b32 v57, v9, 0, s[32:33]
    v_cndmask_b32 v80, 0, v8, s[32:33]
    v_cndmask_b32 v81, 0, v9, s[32:33]
    v_lshlrev_b32 v8, 16, v33
    v_and_b32 v9, 0xffff0000, v33
    v_cndmask_b32 v58, v8, 0, s[32:33]
    v_cndmask_b32 v59, v9, 0, s[32:33]
    v_cndmask_b32 v82, 0, v8, s[32:33]
    v_cndmask_b32 v83, 0, v9, s[32:33]
    v_lshlrev_b32 v8, 16, v34
    v_and_b32 v9, 0xffff0000, v34
    v_cndmask_b32 v60, v8, 0, s[32:33]
    v_cndmask_b32 v61, v9, 0, s[32:33]
    v_cndmask_b32 v84, 0, v8, s[32:33]
    v_cndmask_b32 v85, 0, v9, s[32:33]
    v_lshlrev_b32 v8, 16, v35
    v_and_b32 v9, 0xffff0000, v35
    v_cndmask_b32 v62, v8, 0, s[32:33]
    v_cndmask_b32 v63, v9, 0, s[32:33]
    v_cndmask_b32 v86, 0, v8, s[32:33]
    v_cndmask_b32 v87, 0, v9, s[32:33]
    v_lshlrev_b32 v8, 16, v36
    v_and_b32 v9, 0xffff0000, v36
    v_cndmask_b32 v64, v8, 0, s[32:33]
    v_cndmask_b32 v65, v9, 0, s[32:33]
    v_cndmask_b32 v88, 0, v8, s[32:33]
    v_cndmask_b32 v89, 0, v9, s[32:33]
    v_lshlrev_b32 v8, 16, v37
    v_and_b32 v9, 0xffff0000, v37
    v_cndmask_b32 v66, v8, 0, s[32:33]
    v_cndmask_b32 v67, v9, 0, s[32:33]
    v_cndmask_b32 v90, 0, v8, s[32:33]
    v_cndmask_b32 v91, 0, v9, s[32:33]
    v_lshlrev_b32 v8, 16, v38
    v_and_b32 v9, 0xffff0000, v38
    v_cndmask_b32 v68, v8, 0, s[32:33]
    v_cndmask_b32 v69, v9, 0, s[32:33]
    v_cndmask_b32 v92, 0, v8, s[32:33]
    v_cndmask_b32 v93, 0, v9, s[32:33]
    v_lshlrev_b32 v8, 16, v39
    v_and_b32 v9, 0xffff0000, v39
    v_cndmask_b32 v70, v8, 0, s[32:33]
    v_cndmask_b32 v71, v9, 0, s[32:33]
    v_cndmask_b32 v94, 0, v8, s[32:33]
    v_cndmask_b32 v95, 0, v9, s[32:33]
    ds_read_b64_tr_b16 v[24:25], v4 offset:0
    ds_read_b64_tr_b16 v[26:27], v4 offset:768
    ds_read_b64_tr_b16 v[28:29], v4 offset:64
    ds_read_b64_tr_b16 v[30:31], v4 offset:832
    ds_read_b64_tr_b16 v[32:33], v4 offset:128
    ds_read_b64_tr_b16 v[34:35], v4 offset:896
    s_lshr_b32 s23, s75, 2
    s_lshl_b32 s23, s23, 7
    s_add_u32 s23, s23, 14704640
    v_lshlrev_b32 v8, 2, v2
    s_mov_b32 s24, 0
k2_attn_kernel_poll:
    buffer_load_dword v9, v8, s[12:15], s23 offen sc1
    s_add_u32 s24, s24, 1
    s_waitcnt vmcnt(0)
    v_cmp_ne_u32 vcc, 1, v9
    s_cmp_gt_u32 s24, 40000
    s_cbranch_scc1 k2_attn_kernel_go
    s_cbranch_vccnz k2_attn_kernel_poll
k2_attn_kernel_go:
    s_cmp_eq_u32 s78, 1
    s_cbranch_scc1 k2_attn_kernel_oext
    buffer_load_dwordx4 v[96:99], v7, s[12:15], s35 offen offset:0 sc1
    buffer_load_dwordx4 v[100:103], v7, s[12:15], s35 offen offset:1024 sc1
    buffer_load_dwordx4 v[104:107], v7, s[12:15], s35 offen offset:2048 sc1
    buffer_load_dwordx4 v[108:111], v7, s[12:15], s35 offen offset:3072 sc1
    s_add_u32 s35, s35, 4096
    buffer_load_dwordx4 v[112:115], v7, s[12:15], s35 offen offset:0 sc1
    buffer_load_dwordx4 v[116:119], v7, s[12:15], s35 offen offset:1024 sc1
    buffer_load_dwordx4 v[120:123], v7, s[12:15], s35 offen offset:2048 sc1
    buffer_load_dwordx4 v[124:127], v7, s[12:15], s35 offen offset:3072 sc1
    s_add_u32 s35, s35, 4096
    s_waitcnt vmcnt(7) lgkmcnt(0)
    v_mfma_f32_32x32x16_bf16 v[48:63], v[24:27], v[96:99], v[48:63]
    ds_read_b64_tr_b16 v[36:37], v4 offset:3072
    ds_read_b64_tr_b16 v[38:39], v4 offset:3840
    ds_read_b64_tr_b16 v[40:41], v4 offset:3136
    ds_read_b64_tr_b16 v[42:43], v4 offset:3904
    ds_read_b64_tr_b16 v[44:45], v4 offset:3200
    ds_read_b64_tr_b16 v[46:47], v4 offset:3968
    v_mfma_f32_32x32x16_bf16 v[64:79], v[28:31], v[96:99], v[64:79]
    buffer_load_dwordx4 v[128:131], v7, s[12:15], s35 offen offset:0 sc1
    v_mfma_f32_32x32x16_bf16 v[80:95], v[32:35], v[96:99], v[80:95]
    s_waitcnt vmcnt(7) lgkmcnt(0)
    v_mfma_f32_32x32x16_bf16 v[48:63], v[36:39], v[100:103], v[48:63]
    ds_read_b64_tr_b16 v[24:25], v4 offset:6144
    ds_read_b64_tr_b16 v[26:27], v4 offset:6912
    ds_read_b64_tr_b16 v[28:29], v4 offset:6208
    ds_read_b64_tr_b16 v[30:31], v4 offset:6976
    ds_read_b64_tr_b16 v[32:33], v4 offset:6272
    ds_read_b64_tr_b16 v[34:35], v4 offset:7040
    v_mfma_f32_32x32x16_bf16 v[64:79], v[40:43], v[100:103], v[64:79]
    buffer_load_dwordx4 v[132:135], v7, s[12:15], s35 offen offset:1024 sc1
    v_mfma_f32_32x32x16_bf16 v[80:95], v[44:47], v[100:103], v[80:95]
    s_waitcnt vmcnt(7) lgkmcnt(0)
    v_mfma_f32_32x32x16_bf16 v[48:63], v[24:27], v[104:107], v[48:63]
    ds_read_b64_tr_b16 v[36:37], v4 offset:9216
    ds_read_b64_tr_b16 v[38:39], v4 offset:9984
    ds_read_b64_tr_b16 v[40:41], v4 offset:9280
    ds_read_b64_tr_b16 v[42:43], v4 offset:10048
    ds_read_b64_tr_b16 v[44:45], v4 offset:9344
    ds_read_b64_tr_b16 v[46:47], v4 offset:10112
    v_mfma_f32_32x32x16_bf16 v[64:79], v[28:31], v[104:107], v[64:79]
    buffer_load_dwordx4 v[136:139], v7, s[12:15], s35 offen offset:2048 sc1
    v_mfma_f32_32x32x16_bf16 v[80:95], v[32:35], v[104:107], v[80:95]
    s_waitcnt vmcnt(7) lgkmcnt(0)
    v_mfma_f32_32x32x16_bf16 v[48:63], v[36:39], v[108:111], v[48:63]
    ds_read_b64_tr_b16 v[24:25], v4 offset:12288
    ds_read_b64_tr_b16 v[26:27], v4 offset:13056
    ds_read_b64_tr_b16 v[28:29], v4 offset:12352
    ds_read_b64_tr_b16 v[30:31], v4 offset:13120
    ds_read_b64_tr_b16 v[32:33], v4 offset:12416
    ds_read_b64_tr_b16 v[34:35], v4 offset:13184
    v_mfma_f32_32x32x16_bf16 v[64:79], v[40:43], v[108:111], v[64:79]
    buffer_load_dwordx4 v[140:143], v7, s[12:15], s35 offen offset:3072 sc1
    s_add_u32 s35, s35, 4096
    v_mfma_f32_32x32x16_bf16 v[80:95], v[44:47], v[108:111], v[80:95]
    s_waitcnt vmcnt(7) lgkmcnt(0)
    v_mfma_f32_32x32x16_bf16 v[48:63], v[24:27], v[112:115], v[48:63]
    ds_read_b64_tr_b16 v[36:37], v4 offset:15360
    ds_read_b64_tr_b16 v[38:39], v4 offset:16128
    ds_read_b64_tr_b16 v[40:41], v4 offset:15424
    ds_read_b64_tr_b16 v[42:43], v4 offset:16192
    ds_read_b64_tr_b16 v[44:45], v4 offset:15488
    ds_read_b64_tr_b16 v[46:47], v4 offset:16256
    v_mfma_f32_32x32x16_bf16 v[64:79], v[28:31], v[112:115], v[64:79]
    buffer_load_dwordx4 v[144:147], v7, s[12:15], s35 offen offset:0 sc1
    v_mfma_f32_32x32x16_bf16 v[80:95], v[32:35], v[112:115], v[80:95]
    s_waitcnt vmcnt(7) lgkmcnt(0)
    v_mfma_f32_32x32x16_bf16 v[48:63], v[36:39], v[116:119], v[48:63]
    ds_read_b64_tr_b16 v[24:25], v4 offset:18432
    ds_read_b64_tr_b16 v[26:27], v4 offset:19200
    ds_read_b64_tr_b16 v[28:29], v4 offset:18496
    ds_read_b64_tr_b16 v[30:31], v4 offset:19264
    ds_read_b64_tr_b16 v[32:33], v4 offset:18560
    ds_read_b64_tr_b16 v[34:35], v4 offset:19328
    v_mfma_f32_32x32x16_bf16 v[64:79], v[40:43], v[116:119], v[64:79]
    buffer_load_dwordx4 v[148:151], v7, s[12:15], s35 offen offset:1024 sc1
    v_mfma_f32_32x32x16_bf16 v[80:95], v[44:47], v[116:119], v[80:95]
    s_waitcnt vmcnt(7) lgkmcnt(0)
    v_mfma_f32_32x32x16_bf16 v[48:63], v[24:27], v[120:123], v[48:63]
    ds_read_b64_tr_b16 v[36:37], v4 offset:21504
    ds_read_b64_tr_b16 v[38:39], v4 offset:22272
    ds_read_b64_tr_b16 v[40:41], v4 offset:21568
    ds_read_b64_tr_b16 v[42:43], v4 offset:22336
    ds_read_b64_tr_b16 v[44:45], v4 offset:21632
    ds_read_b64_tr_b16 v[46:47], v4 offset:22400
    v_mfma_f32_32x32x16_bf16 v[64:79], v[28:31], v[120:123], v[64:79]
    buffer_load_dwordx4 v[152:155], v7, s[12:15], s35 offen offset:2048 sc1
    v_mfma_f32_32x32x16_bf16 v[80:95], v[32:35], v[120:123], v[80:95]
    s_waitcnt vmcnt(7) lgkmcnt(0)
    v_mfma_f32_32x32x16_bf16 v[48:63], v[36:39], v[124:127], v[48:63]
    ds_read_b64_tr_b16 v[24:25], v4 offset:24576
    ds_read_b64_tr_b16 v[26:27], v4 offset:25344
    ds_read_b64_tr_b16 v[28:29], v4 offset:24640
    ds_read_b64_tr_b16 v[30:31], v4 offset:25408
    ds_read_b64_tr_b16 v[32:33], v4 offset:24704
    ds_read_b64_tr_b16 v[34:35], v4 offset:25472
    v_mfma_f32_32x32x16_bf16 v[64:79], v[40:43], v[124:127], v[64:79]
    buffer_load_dwordx4 v[156:159], v7, s[12:15], s35 offen offset:3072 sc1
    s_add_u32 s35, s35, 4096
    v_mfma_f32_32x32x16_bf16 v[80:95], v[44:47], v[124:127], v[80:95]
    s_waitcnt vmcnt(7) lgkmcnt(0)
    v_mfma_f32_32x32x16_bf16 v[48:63], v[24:27], v[128:131], v[48:63]
    ds_read_b64_tr_b16 v[36:37], v4 offset:27648
    ds_read_b64_tr_b16 v[38:39], v4 offset:28416
    ds_read_b64_tr_b16 v[40:41], v4 offset:27712
    ds_read_b64_tr_b16 v[42:43], v4 offset:28480
    ds_read_b64_tr_b16 v[44:45], v4 offset:27776
    ds_read_b64_tr_b16 v[46:47], v4 offset:28544
    v_mfma_f32_32x32x16_bf16 v[64:79], v[28:31], v[128:131], v[64:79]
    buffer_load_dwordx4 v[160:163], v7, s[12:15], s35 offen offset:0 sc1
    v_mfma_f32_32x32x16_bf16 v[80:95], v[32:35], v[128:131], v[80:95]
    s_waitcnt vmcnt(7) lgkmcnt(0)
    v_mfma_f32_32x32x16_bf16 v[48:63], v[36:39], v[132:135], v[48:63]
    ds_read_b64_tr_b16 v[24:25], v4 offset:30720
    ds_read_b64_tr_b16 v[26:27], v4 offset:31488
    ds_read_b64_tr_b16 v[28:29], v4 offset:30784
    ds_read_b64_tr_b16 v[30:31], v4 offset:31552
    ds_read_b64_tr_b16 v[32:33], v4 offset:30848
    ds_read_b64_tr_b16 v[34:35], v4 offset:31616
    v_mfma_f32_32x32x16_bf16 v[64:79], v[40:43], v[132:135], v[64:79]
    buffer_load_dwordx4 v[164:167], v7, s[12:15], s35 offen offset:1024 sc1
    v_mfma_f32_32x32x16_bf16 v[80:95], v[44:47], v[132:135], v[80:95]
    s_waitcnt vmcnt(7) lgkmcnt(0)
    v_mfma_f32_32x32x16_bf16 v[48:63], v[24:27], v[136:139], v[48:63]
    ds_read_b64_tr_b16 v[36:37], v4 offset:33792
    ds_read_b64_tr_b16 v[38:39], v4 offset:34560
    ds_read_b64_tr_b16 v[40:41], v4 offset:33856
    ds_read_b64_tr_b16 v[42:43], v4 offset:34624
    ds_read_b64_tr_b16 v[44:45], v4 offset:33920
    ds_read_b64_tr_b16 v[46:47], v4 offset:34688
    v_mfma_f32_32x32x16_bf16 v[64:79], v[28:31], v[136:139], v[64:79]
    v_mfma_f32_32x32x16_bf16 v[80:95], v[32:35], v[136:139], v[80:95]
    s_waitcnt vmcnt(6) lgkmcnt(0)
    v_mfma_f32_32x32x16_bf16 v[48:63], v[36:39], v[140:143], v[48:63]
    ds_read_b64_tr_b16 v[24:25], v4 offset:36864
    ds_read_b64_tr_b16 v[26:27], v4 offset:37632
    ds_read_b64_tr_b16 v[28:29], v4 offset:36928
    ds_read_b64_tr_b16 v[30:31], v4 offset:37696
    ds_read_b64_tr_b16 v[32:33], v4 offset:36992
    ds_read_b64_tr_b16 v[34:35], v4 offset:37760
    v_mfma_f32_32x32x16_bf16 v[64:79], v[40:43], v[140:143], v[64:79]
    v_mfma_f32_32x32x16_bf16 v[80:95], v[44:47], v[140:143], v[80:95]
    s_waitcnt vmcnt(5) lgkmcnt(0)
    v_mfma_f32_32x32x16_bf16 v[48:63], v[24:27], v[144:147], v[48:63]
    ds_read_b64_tr_b16 v[36:37], v4 offset:39936
    ds_read_b64_tr_b16 v[38:39], v4 offset:40704
    ds_read_b64_tr_b16 v[40:41], v4 offset:40000
    ds_read_b64_tr_b16 v[42:43], v4 offset:40768
    ds_read_b64_tr_b16 v[44:45], v4 offset:40064
    ds_read_b64_tr_b16 v[46:47], v4 offset:40832
    v_mfma_f32_32x32x16_bf16 v[64:79], v[28:31], v[144:147], v[64:79]
    v_mfma_f32_32x32x16_bf16 v[80:95], v[32:35], v[144:147], v[80:95]
    s_waitcnt vmcnt(4) lgkmcnt(0)
    v_mfma_f32_32x32x16_bf16 v[48:63], v[36:39], v[148:151], v[48:63]
    ds_read_b64_tr_b16 v[24:25], v4 offset:43008
    ds_read_b64_tr_b16 v[26:27], v4 offset:43776
    ds_read_b64_tr_b16 v[28:29], v4 offset:43072
    ds_read_b64_tr_b16 v[30:31], v4 offset:43840
    ds_read_b64_tr_b16 v[32:33], v4 offset:43136
    ds_read_b64_tr_b16 v[34:35], v4 offset:43904
    v_mfma_f32_32x32x16_bf16 v[64:79], v[40:43], v[148:151], v[64:79]
    v_mfma_f32_32x32x16_bf16 v[80:95], v[44:47], v[148:151], v[80:95]
    s_waitcnt vmcnt(3) lgkmcnt(0)
    v_mfma_f32_32x32x16_bf16 v[48:63], v[24:27], v[152:155], v[48:63]
    ds_read_b64_tr_b16 v[36:37], v4 offset:46080
    ds_read_b64_tr_b16 v[38:39], v4 offset:46848
    ds_read_b64_tr_b16 v[40:41], v4 offset:46144
    ds_read_b64_tr_b16 v[42:43], v4 offset:46912
    ds_read_b64_tr_b16 v[44:45], v4 offset:46208
    ds_read_b64_tr_b16 v[46:47], v4 offset:46976
    v_mfma_f32_32x32x16_bf16 v[64:79], v[28:31], v[152:155], v[64:79]
    v_mfma_f32_32x32x16_bf16 v[80:95], v[32:35], v[152:155], v[80:95]
    s_waitcnt vmcnt(2) lgkmcnt(0)
    v_mfma_f32_32x32x16_bf16 v[48:63], v[36:39], v[156:159], v[48:63]
    ds_read_b64_tr_b16 v[24:25], v4 offset:49152
    ds_read_b64_tr_b16 v[26:27], v4 offset:49920
    ds_read_b64_tr_b16 v[28:29], v4 offset:49216
    ds_read_b64_tr_b16 v[30:31], v4 offset:49984
    ds_read_b64_tr_b16 v[32:33], v4 offset:49280
    ds_read_b64_tr_b16 v[34:35], v4 offset:50048
    v_mfma_f32_32x32x16_bf16 v[64:79], v[40:43], v[156:159], v[64:79]
    v_mfma_f32_32x32x16_bf16 v[80:95], v[44:47], v[156:159], v[80:95]
    s_waitcnt vmcnt(1) lgkmcnt(0)
    v_mfma_f32_32x32x16_bf16 v[48:63], v[24:27], v[160:163], v[48:63]
    ds_read_b64_tr_b16 v[36:37], v4 offset:52224
    ds_read_b64_tr_b16 v[38:39], v4 offset:52992
    ds_read_b64_tr_b16 v[40:41], v4 offset:52288
    ds_read_b64_tr_b16 v[42:43], v4 offset:53056
    ds_read_b64_tr_b16 v[44:45], v4 offset:52352
    ds_read_b64_tr_b16 v[46:47], v4 offset:53120
    v_mfma_f32_32x32x16_bf16 v[64:79], v[28:31], v[160:163], v[64:79]
    v_mfma_f32_32x32x16_bf16 v[80:95], v[32:35], v[160:163], v[80:95]
    s_waitcnt vmcnt(0) lgkmcnt(0)
    v_mfma_f32_32x32x16_bf16 v[48:63], v[36:39], v[164:167], v[48:63]
    v_mfma_f32_32x32x16_bf16 v[64:79], v[40:43], v[164:167], v[64:79]
    v_mfma_f32_32x32x16_bf16 v[80:95], v[44:47], v[164:167], v[80:95]
    s_branch k2_attn_kernel_odone
k2_attn_kernel_oext:
    buffer_load_dwordx4 v[96:99], v7, s[12:15], s35 offen offset:0 sc1
    buffer_load_dwordx4 v[100:103], v7, s[12:15], s35 offen offset:1024 sc1
    buffer_load_dwordx4 v[104:107], v7, s[12:15], s35 offen offset:2048 sc1
    buffer_load_dwordx4 v[108:111], v7, s[12:15], s35 offen offset:3072 sc1
    s_add_u32 s35, s35, 4096
    buffer_load_dwordx4 v[112:115], v7, s[12:15], s35 offen offset:0 sc1
    buffer_load_dwordx4 v[116:119], v7, s[12:15], s35 offen offset:1024 sc1
    buffer_load_dwordx4 v[120:123], v7, s[12:15], s35 offen offset:2048 sc1
    buffer_load_dwordx4 v[124:127], v7, s[12:15], s35 offen offset:3072 sc1
    s_add_u32 s35, s35, 4096
    s_waitcnt vmcnt(7) lgkmcnt(0)
    v_mfma_f32_32x32x16_bf16 v[48:63], v[24:27], v[96:99], v[48:63]
    ds_read_b64_tr_b16 v[36:37], v4 offset:3072
    ds_read_b64_tr_b16 v[38:39], v4 offset:3840
    ds_read_b64_tr_b16 v[40:41], v4 offset:3136
    ds_read_b64_tr_b16 v[42:43], v4 offset:3904
    ds_read_b64_tr_b16 v[44:45], v4 offset:3200
    ds_read_b64_tr_b16 v[46:47], v4 offset:3968
    v_mfma_f32_32x32x16_bf16 v[64:79], v[28:31], v[96:99], v[64:79]
    buffer_load_dwordx4 v[128:131], v7, s[12:15], s35 offen offset:0 sc1
    v_mfma_f32_32x32x16_bf16 v[80:95], v[32:35], v[96:99], v[80:95]
    s_waitcnt vmcnt(7) lgkmcnt(0)
    v_mfma_f32_32x32x16_bf16 v[48:63], v[36:39], v[100:103], v[48:63]
    ds_read_b64_tr_b16 v[24:25], v4 offset:6144
    ds_read_b64_tr_b16 v[26:27], v4 offset:6912
    ds_read_b64_tr_b16 v[28:29], v4 offset:6208
    ds_read_b64_tr_b16 v[30:31], v4 offset:6976
    ds_read_b64_tr_b16 v[32:33], v4 offset:6272
    ds_read_b64_tr_b16 v[34:35], v4 offset:7040
    v_mfma_f32_32x32x16_bf16 v[64:79], v[40:43], v[100:103], v[64:79]
    buffer_load_dwordx4 v[132:135], v7, s[12:15], s35 offen offset:1024 sc1
    v_mfma_f32_32x32x16_bf16 v[80:95], v[44:47], v[100:103], v[80:95]
    s_waitcnt vmcnt(7) lgkmcnt(0)
    v_mfma_f32_32x32x16_bf16 v[48:63], v[24:27], v[104:107], v[48:63]
    ds_read_b64_tr_b16 v[36:37], v4 offset:9216
    ds_read_b64_tr_b16 v[38:39], v4 offset:9984
    ds_read_b64_tr_b16 v[40:41], v4 offset:9280
    ds_read_b64_tr_b16 v[42:43], v4 offset:10048
    ds_read_b64_tr_b16 v[44:45], v4 offset:9344
    ds_read_b64_tr_b16 v[46:47], v4 offset:10112
    v_mfma_f32_32x32x16_bf16 v[64:79], v[28:31], v[104:107], v[64:79]
    buffer_load_dwordx4 v[136:139], v7, s[12:15], s35 offen offset:2048 sc1
    v_mfma_f32_32x32x16_bf16 v[80:95], v[32:35], v[104:107], v[80:95]
    s_waitcnt vmcnt(7) lgkmcnt(0)
    v_mfma_f32_32x32x16_bf16 v[48:63], v[36:39], v[108:111], v[48:63]
    ds_read_b64_tr_b16 v[24:25], v4 offset:12288
    ds_read_b64_tr_b16 v[26:27], v4 offset:13056
    ds_read_b64_tr_b16 v[28:29], v4 offset:12352
    ds_read_b64_tr_b16 v[30:31], v4 offset:13120
    ds_read_b64_tr_b16 v[32:33], v4 offset:12416
    ds_read_b64_tr_b16 v[34:35], v4 offset:13184
    v_mfma_f32_32x32x16_bf16 v[64:79], v[40:43], v[108:111], v[64:79]
    buffer_load_dwordx4 v[140:143], v7, s[12:15], s35 offen offset:3072 sc1
    s_add_u32 s35, s35, 4096
    v_mfma_f32_32x32x16_bf16 v[80:95], v[44:47], v[108:111], v[80:95]
    s_waitcnt vmcnt(7) lgkmcnt(0)
    v_mfma_f32_32x32x16_bf16 v[48:63], v[24:27], v[112:115], v[48:63]
    ds_read_b64_tr_b16 v[36:37], v4 offset:15360
    ds_read_b64_tr_b16 v[38:39], v4 offset:16128
    ds_read_b64_tr_b16 v[40:41], v4 offset:15424
    ds_read_b64_tr_b16 v[42:43], v4 offset:16192
    ds_read_b64_tr_b16 v[44:45], v4 offset:15488
    ds_read_b64_tr_b16 v[46:47], v4 offset:16256
    v_mfma_f32_32x32x16_bf16 v[64:79], v[28:31], v[112:115], v[64:79]
    buffer_load_dwordx4 v[144:147], v7, s[12:15], s35 offen offset:0 sc1
    v_mfma_f32_32x32x16_bf16 v[80:95], v[32:35], v[112:115], v[80:95]
    s_waitcnt vmcnt(7) lgkmcnt(0)
    v_mfma_f32_32x32x16_bf16 v[48:63], v[36:39], v[116:119], v[48:63]
    ds_read_b64_tr_b16 v[24:25], v4 offset:18432
    ds_read_b64_tr_b16 v[26:27], v4 offset:19200
    ds_read_b64_tr_b16 v[28:29], v4 offset:18496
    ds_read_b64_tr_b16 v[30:31], v4 offset:19264
    ds_read_b64_tr_b16 v[32:33], v4 offset:18560
    ds_read_b64_tr_b16 v[34:35], v4 offset:19328
    v_mfma_f32_32x32x16_bf16 v[64:79], v[40:43], v[116:119], v[64:79]
    buffer_load_dwordx4 v[148:151], v7, s[12:15], s35 offen offset:1024 sc1
    v_mfma_f32_32x32x16_bf16 v[80:95], v[44:47], v[116:119], v[80:95]
    s_waitcnt vmcnt(7) lgkmcnt(0)
    v_mfma_f32_32x32x16_bf16 v[48:63], v[24:27], v[120:123], v[48:63]
    ds_read_b64_tr_b16 v[36:37], v4 offset:21504
    ds_read_b64_tr_b16 v[38:39], v4 offset:22272
    ds_read_b64_tr_b16 v[40:41], v4 offset:21568
    ds_read_b64_tr_b16 v[42:43], v4 offset:22336
    ds_read_b64_tr_b16 v[44:45], v4 offset:21632
    ds_read_b64_tr_b16 v[46:47], v4 offset:22400
    v_mfma_f32_32x32x16_bf16 v[64:79], v[28:31], v[120:123], v[64:79]
    buffer_load_dword v152, v6, s[12:15], s62 offen offset:0 sc1
    buffer_load_dword v153, v6, s[12:15], s62 offen offset:128 sc1
    buffer_load_dword v154, v6, s[12:15], s62 offen offset:256 sc1
    buffer_load_dword v155, v6, s[12:15], s62 offen offset:384 sc1
    v_mfma_f32_32x32x16_bf16 v[80:95], v[32:35], v[120:123], v[80:95]
    s_waitcnt vmcnt(10) lgkmcnt(0)
    v_mfma_f32_32x32x16_bf16 v[48:63], v[36:39], v[124:127], v[48:63]
    ds_read_b64_tr_b16 v[24:25], v4 offset:24576
    ds_read_b64_tr_b16 v[26:27], v4 offset:25344
    ds_read_b64_tr_b16 v[28:29], v4 offset:24640
    ds_read_b64_tr_b16 v[30:31], v4 offset:25408
    ds_read_b64_tr_b16 v[32:33], v4 offset:24704
    ds_read_b64_tr_b16 v[34:35], v4 offset:25472
    v_mfma_f32_32x32x16_bf16 v[64:79], v[40:43], v[124:127], v[64:79]
    buffer_load_dword v156, v6, s[12:15], s62 offen offset:1024 sc1
    buffer_load_dword v157, v6, s[12:15], s62 offen offset:1152 sc1
    buffer_load_dword v158, v6, s[12:15], s62 offen offset:1280 sc1
    buffer_load_dword v159, v6, s[12:15], s62 offen offset:1408 sc1
    v_mfma_f32_32x32x16_bf16 v[80:95], v[44:47], v[124:127], v[80:95]
    s_waitcnt vmcnt(13) lgkmcnt(0)
    v_mfma_f32_32x32x16_bf16 v[48:63], v[24:27], v[128:131], v[48:63]
    ds_read_b64_tr_b16 v[36:37], v4 offset:27648
    ds_read_b64_tr_b16 v[38:39], v4 offset:28416
    ds_read_b64_tr_b16 v[40:41], v4 offset:27712
    ds_read_b64_tr_b16 v[42:43], v4 offset:28480
    ds_read_b64_tr_b16 v[44:45], v4 offset:27776
    ds_read_b64_tr_b16 v[46:47], v4 offset:28544
    v_mfma_f32_32x32x16_bf16 v[64:79], v[28:31], v[128:131], v[64:79]
    buffer_load_dword v160, v6, s[12:15], s62 offen offset:2048 sc1
    buffer_load_dword v161, v6, s[12:15], s62 offen offset:2176 sc1
    buffer_load_dword v162, v6, s[12:15], s62 offen offset:2304 sc1
    buffer_load_dword v163, v6, s[12:15], s62 offen offset:2432 sc1
    v_mfma_f32_32x32x16_bf16 v[80:95], v[32:35], v[128:131], v[80:95]
    s_waitcnt vmcnt(16) lgkmcnt(0)
    v_mfma_f32_32x32x16_bf16 v[48:63], v[36:39], v[132:135], v[48:63]
    ds_read_b64_tr_b16 v[24:25], v4 offset:30720
    ds_read_b64_tr_b16 v[26:27], v4 offset:31488
    ds_read_b64_tr_b16 v[28:29], v4 offset:30784
    ds_read_b64_tr_b16 v[30:31], v4 offset:31552
    ds_read_b64_tr_b16 v[32:33], v4 offset:30848
    ds_read_b64_tr_b16 v[34:35], v4 offset:31616
    v_mfma_f32_32x32x16_bf16 v[64:79], v[40:43], v[132:135], v[64:79]
    buffer_load_dword v164, v6, s[12:15], s62 offen offset:3072 sc1
    buffer_load_dword v165, v6, s[12:15], s62 offen offset:3200 sc1
    buffer_load_dword v166, v6, s[12:15], s62 offen offset:3328 sc1
    buffer_load_dword v167, v6, s[12:15], s62 offen offset:3456 sc1
    v_mfma_f32_32x32x16_bf16 v[80:95], v[44:47], v[132:135], v[80:95]
    s_waitcnt vmcnt(19) lgkmcnt(0)
    v_mfma_f32_32x32x16_bf16 v[48:63], v[24:27], v[136:139], v[48:63]
    ds_read_b64_tr_b16 v[36:37], v4 offset:33792
    ds_read_b64_tr_b16 v[38:39], v4 offset:34560
    ds_read_b64_tr_b16 v[40:41], v4 offset:33856
    ds_read_b64_tr_b16 v[42:43], v4 offset:34624
    ds_read_b64_tr_b16 v[44:45], v4 offset:33920
    ds_read_b64_tr_b16 v[46:47], v4 offset:34688
    v_mfma_f32_32x32x16_bf16 v[64:79], v[28:31], v[136:139], v[64:79]
    v_mfma_f32_32x32x16_bf16 v[80:95], v[32:35], v[136:139], v[80:95]
    s_waitcnt vmcnt(18) lgkmcnt(0)
    v_mfma_f32_32x32x16_bf16 v[48:63], v[36:39], v[140:143], v[48:63]
    ds_read_b64_tr_b16 v[24:25], v4 offset:36864
    ds_read_b64_tr_b16 v[26:27], v4 offset:37632
    ds_read_b64_tr_b16 v[28:29], v4 offset:36928
    ds_read_b64_tr_b16 v[30:31], v4 offset:37696
    ds_read_b64_tr_b16 v[32:33], v4 offset:36992
    ds_read_b64_tr_b16 v[34:35], v4 offset:37760
    v_mfma_f32_32x32x16_bf16 v[64:79], v[40:43], v[140:143], v[64:79]
    v_mfma_f32_32x32x16_bf16 v[80:95], v[44:47], v[140:143], v[80:95]
    s_waitcnt vmcnt(17) lgkmcnt(0)
    v_mfma_f32_32x32x16_bf16 v[48:63], v[24:27], v[144:147], v[48:63]
    ds_read_b64_tr_b16 v[36:37], v4 offset:39936
    ds_read_b64_tr_b16 v[38:39], v4 offset:40704
    ds_read_b64_tr_b16 v[40:41], v4 offset:40000
    ds_read_b64_tr_b16 v[42:43], v4 offset:40768
    ds_read_b64_tr_b16 v[44:45], v4 offset:40064
    ds_read_b64_tr_b16 v[46:47], v4 offset:40832
    v_mfma_f32_32x32x16_bf16 v[64:79], v[28:31], v[144:147], v[64:79]
    v_mfma_f32_32x32x16_bf16 v[80:95], v[32:35], v[144:147], v[80:95]
    s_waitcnt vmcnt(16) lgkmcnt(0)
    v_mfma_f32_32x32x16_bf16 v[48:63], v[36:39], v[148:151], v[48:63]
    ds_read_b64_tr_b16 v[24:25], v4 offset:43008
    ds_read_b64_tr_b16 v[26:27], v4 offset:43776
    ds_read_b64_tr_b16 v[28:29], v4 offset:43072
    ds_read_b64_tr_b16 v[30:31], v4 offset:43840
    ds_read_b64_tr_b16 v[32:33], v4 offset:43136
    ds_read_b64_tr_b16 v[34:35], v4 offset:43904
    v_mfma_f32_32x32x16_bf16 v[64:79], v[40:43], v[148:151], v[64:79]
    v_mfma_f32_32x32x16_bf16 v[80:95], v[44:47], v[148:151], v[80:95]
    s_waitcnt vmcnt(12) lgkmcnt(0)
    v_mfma_f32_32x32x16_bf16 v[48:63], v[24:27], v[152:155], v[48:63]
    ds_read_b64_tr_b16 v[36:37], v4 offset:46080
    ds_read_b64_tr_b16 v[38:39], v4 offset:46848
    ds_read_b64_tr_b16 v[40:41], v4 offset:46144
    ds_read_b64_tr_b16 v[42:43], v4 offset:46912
    ds_read_b64_tr_b16 v[44:45], v4 offset:46208
    ds_read_b64_tr_b16 v[46:47], v4 offset:46976
    v_mfma_f32_32x32x16_bf16 v[64:79], v[28:31], v[152:155], v[64:79]
    v_mfma_f32_32x32x16_bf16 v[80:95], v[32:35], v[152:155], v[80:95]
    s_waitcnt vmcnt(8) lgkmcnt(0)
    v_mfma_f32_32x32x16_bf16 v[48:63], v[36:39], v[156:159], v[48:63]
    ds_read_b64_tr_b16 v[24:25], v4 offset:49152
    ds_read_b64_tr_b16 v[26:27], v4 offset:49920
    ds_read_b64_tr_b16 v[28:29], v4 offset:49216
    ds_read_b64_tr_b16 v[30:31], v4 offset:49984
    ds_read_b64_tr_b16 v[32:33], v4 offset:49280
    ds_read_b64_tr_b16 v[34:35], v4 offset:50048
    v_mfma_f32_32x32x16_bf16 v[64:79], v[40:43], v[156:159], v[64:79]
    v_mfma_f32_32x32x16_bf16 v[80:95], v[44:47], v[156:159], v[80:95]
    s_waitcnt vmcnt(4) lgkmcnt(0)
    v_mfma_f32_32x32x16_bf16 v[48:63], v[24:27], v[160:163], v[48:63]
    ds_read_b64_tr_b16 v[36:37], v4 offset:52224
    ds_read_b64_tr_b16 v[38:39], v4 offset:52992
    ds_read_b64_tr_b16 v[40:41], v4 offset:52288
    ds_read_b64_tr_b16 v[42:43], v4 offset:53056
    ds_read_b64_tr_b16 v[44:45], v4 offset:52352
    ds_read_b64_tr_b16 v[46:47], v4 offset:53120
    v_mfma_f32_32x32x16_bf16 v[64:79], v[28:31], v[160:163], v[64:79]
    v_mfma_f32_32x32x16_bf16 v[80:95], v[32:35], v[160:163], v[80:95]
    s_waitcnt vmcnt(0) lgkmcnt(0)
    v_mfma_f32_32x32x16_bf16 v[48:63], v[36:39], v[164:167], v[48:63]
    v_mfma_f32_32x32x16_bf16 v[64:79], v[40:43], v[164:167], v[64:79]
    v_mfma_f32_32x32x16_bf16 v[80:95], v[44:47], v[164:167], v[80:95]
k2_attn_kernel_odone:
    s_mul_i32 s23, s22, 6144
    s_xor_b32 s24, s22, 2
    s_mul_i32 s24, s24, 6144
    s_add_u32 s23, s23, 0
    s_add_u32 s24, s24, 0
    v_add_u32 v8, s23, v7
    v_add_u32 v9, s24, v7
    s_nop 7
    v_mov_b32 v10, 155676
    v_mov_b32 v11, 1
    s_mov_b64 exec, 1
    ds_add_u32 v10, v11
    s_mov_b64 exec, -1
    v_cndmask_b32 v96, v72, v48, s[32:33]
    v_cndmask_b32 v97, v73, v49, s[32:33]
    v_cndmask_b32 v98, v74, v50, s[32:33]
    v_cndmask_b32 v99, v75, v51, s[32:33]
    v_cndmask_b32 v100, v76, v52, s[32:33]
    v_cndmask_b32 v101, v77, v53, s[32:33]
    v_cndmask_b32 v102, v78, v54, s[32:33]
    v_cndmask_b32 v103, v79, v55, s[32:33]
    v_cndmask_b32 v104, v80, v56, s[32:33]
    v_cndmask_b32 v105, v81, v57, s[32:33]
    v_cndmask_b32 v106, v82, v58, s[32:33]
    v_cndmask_b32 v107, v83, v59, s[32:33]
    v_cndmask_b32 v108, v84, v60, s[32:33]
    v_cndmask_b32 v109, v85, v61, s[32:33]
    v_cndmask_b32 v110, v86, v62, s[32:33]
    v_cndmask_b32 v111, v87, v63, s[32:33]
    v_cndmask_b32 v112, v88, v64, s[32:33]
    v_cndmask_b32 v113, v89, v65, s[32:33]
    v_cndmask_b32 v114, v90, v66, s[32:33]
    v_cndmask_b32 v115, v91, v67, s[32:33]
    v_cndmask_b32 v116, v92, v68, s[32:33]
    v_cndmask_b32 v117, v93, v69, s[32:33]
    v_cndmask_b32 v118, v94, v70, s[32:33]
    v_cndmask_b32 v119, v95, v71, s[32:33]
    v_mov_b32 v10, 155676
    s_mov_b32 s23, 0
k2_attn_kernel_lw1:
    ds_read_b32 v11, v10
    s_add_u32 s23, s23, 1
    s_waitcnt lgkmcnt(0)
    v_readfirstlane_b32 s24, v11
    s_nop 0
    s_cmp_ge_u32 s24, 4
    s_cbranch_scc1 k2_attn_kernel_lwd1
    s_nop 0
    s_cmp_lt_u32 s23, 0x800000
    s_cbranch_scc1 k2_attn_kernel_lw1
k2_attn_kernel_lwd1:
    ds_write_b128 v8, v[96:99] offset:0
    ds_write_b128 v8, v[100:103] offset:1024
    ds_write_b128 v8, v[104:107] offset:2048
    ds_write_b128 v8, v[108:111] offset:3072
    ds_write_b128 v8, v[112:115] offset:4096
    ds_write_b128 v8, v[116:119] offset:5120
    v_cndmask_b32 v120, v48, v72, s[32:33]
    v_cndmask_b32 v121, v49, v73, s[32:33]
    v_cndmask_b32 v122, v50, v74, s[32:33]
    v_cndmask_b32 v123, v51, v75, s[32:33]
    v_cndmask_b32 v124, v52, v76, s[32:33]
    v_cndmask_b32 v125, v53, v77, s[32:33]
    v_cndmask_b32 v126, v54, v78, s[32:33]
    v_cndmask_b32 v127, v55, v79, s[32:33]
    v_cndmask_b32 v128, v56, v80, s[32:33]
    v_cndmask_b32 v129, v57, v81, s[32:33]
    v_cndmask_b32 v130, v58, v82, s[32:33]
    v_cndmask_b32 v131, v59, v83, s[32:33]
    v_cndmask_b32 v132, v60, v84, s[32:33]
    v_cndmask_b32 v133, v61, v85, s[32:33]
    v_cndmask_b32 v134, v62, v86, s[32:33]
    v_cndmask_b32 v135, v63, v87, s[32:33]
    v_cndmask_b32 v136, v64, v88, s[32:33]
    v_cndmask_b32 v137, v65, v89, s[32:33]
    v_cndmask_b32 v138, v66, v90, s[32:33]
    v_cndmask_b32 v139, v67, v91, s[32:33]
    v_cndmask_b32 v140, v68, v92, s[32:33]
    v_cndmask_b32 v141, v69, v93, s[32:33]
    v_cndmask_b32 v142, v70, v94, s[32:33]
    v_cndmask_b32 v143, v71, v95, s[32:33]
    v_mov_b32 v144, 0
    v_mov_b32 v145, 0
    v_mov_b32 v146, 0
    v_mov_b32 v147, 0x3f803f80
    s_waitcnt lgkmcnt(0)
    v_mov_b32 v10, 155652
    v_mov_b32 v11, 1
    s_mov_b64 exec, 1
    ds_add_u32 v10, v11
    s_mov_b64 exec, -1
    v_mov_b32 v10, 155652
    s_mov_b32 s23, 0
k2_attn_kernel_lw2:
    ds_read_b32 v11, v10
    s_add_u32 s23, s23, 1
    s_waitcnt lgkmcnt(0)
    v_readfirstlane_b32 s24, v11
    s_nop 0
    s_cmp_ge_u32 s24, 4
    s_cbranch_scc1 k2_attn_kernel_lwd2
    s_nop 0
    s_cmp_lt_u32 s23, 0x800000
    s_cbranch_scc1 k2_attn_kernel_lw2
k2_attn_kernel_lwd2:
    ds_read_b128 v[48:51], v9 offset:0
    ds_read_b128 v[52:55], v9 offset:1024
    ds_read_b128 v[56:59], v9 offset:2048
    ds_read_b128 v[60:63], v9 offset:3072
    ds_read_b128 v[64:67], v9 offset:4096
    ds_read_b128 v[68:71], v9 offset:5120
    s_waitcnt lgkmcnt(5)
    v_pk_add_f32 v[120:121], v[120:121], v[48:49]
    v_cvt_pk_bf16_f32 v72, v120, v121
    v_pk_add_f32 v[122:123], v[122:123], v[50:51]
    v_cvt_pk_bf16_f32 v73, v122, v123
    v_dot2c_f32_bf16 v144, v72, v147
    v_dot2c_f32_bf16 v145, v72, v72
    v_dot2c_f32_bf16 v146, v72, v12
    v_dot2c_f32_bf16 v144, v73, v147
    v_dot2c_f32_bf16 v145, v73, v73
    v_dot2c_f32_bf16 v146, v73, v13
    s_waitcnt lgkmcnt(4)
    v_pk_add_f32 v[124:125], v[124:125], v[52:53]
    v_cvt_pk_bf16_f32 v74, v124, v125
    v_pk_add_f32 v[126:127], v[126:127], v[54:55]
    v_cvt_pk_bf16_f32 v75, v126, v127
    v_dot2c_f32_bf16 v144, v74, v147
    v_dot2c_f32_bf16 v145, v74, v74
    v_dot2c_f32_bf16 v146, v74, v14
    v_dot2c_f32_bf16 v144, v75, v147
    v_dot2c_f32_bf16 v145, v75, v75
    v_dot2c_f32_bf16 v146, v75, v15
    s_waitcnt lgkmcnt(3)
    v_pk_add_f32 v[128:129], v[128:129], v[56:57]
    v_cvt_pk_bf16_f32 v76, v128, v129
    v_pk_add_f32 v[130:131], v[130:131], v[58:59]
    v_cvt_pk_bf16_f32 v77, v130, v131
    v_dot2c_f32_bf16 v144, v76, v147
    v_dot2c_f32_bf16 v145, v76, v76
    v_dot2c_f32_bf16 v146, v76, v16
    v_dot2c_f32_bf16 v144, v77, v147
    v_dot2c_f32_bf16 v145, v77, v77
    v_dot2c_f32_bf16 v146, v77, v17
    s_waitcnt lgkmcnt(2)
    v_pk_add_f32 v[132:133], v[132:133], v[60:61]
    v_cvt_pk_bf16_f32 v78, v132, v133
    v_pk_add_f32 v[134:135], v[134:135], v[62:63]
    v_cvt_pk_bf16_f32 v79, v134, v135
    v_dot2c_f32_bf16 v144, v78, v147
    v_dot2c_f32_bf16 v145, v78, v78
    v_dot2c_f32_bf16 v146, v78, v18
    v_dot2c_f32_bf16 v144, v79, v147
    v_dot2c_f32_bf16 v145, v79, v79
    v_dot2c_f32_bf16 v146, v79, v19
    s_waitcnt lgkmcnt(1)
    v_pk_add_f32 v[136:137], v[136:137], v[64:65]
    v_cvt_pk_bf16_f32 v80, v136, v137
    v_pk_add_f32 v[138:139], v[138:139], v[66:67]
    v_cvt_pk_bf16_f32 v81, v138, v139
    v_dot2c_f32_bf16 v144, v80, v147
    v_dot2c_f32_bf16 v145, v80, v80
    v_dot2c_f32_bf16 v146, v80, v20
    v_dot2c_f32_bf16 v144, v81, v147
    v_dot2c_f32_bf16 v145, v81, v81
    v_dot2c_f32_bf16 v146, v81, v21
    s_waitcnt lgkmcnt(0)
    v_pk_add_f32 v[140:141], v[140:141], v[68:69]
    v_cvt_pk_bf16_f32 v82, v140, v141
    v_pk_add_f32 v[142:143], v[142:143], v[70:71]
    v_cvt_pk_bf16_f32 v83, v142, v143
    v_dot2c_f32_bf16 v144, v82, v147
    v_dot2c_f32_bf16 v145, v82, v82
    v_dot2c_f32_bf16 v146, v82, v22
    v_dot2c_f32_bf16 v144, v83, v147
    v_dot2c_f32_bf16 v145, v83, v83
    v_dot2c_f32_bf16 v146, v83, v23
    s_nop 2
    v_mov_b32 v10, v146
    v_permlane32_swap_b32 v144, v145
    s_nop 0
    v_permlane32_swap_b32 v146, v10
    v_add_f32 v144, v144, v145
    v_add_f32 v146, v146, v10
    v_lshlrev_b32 v11, 2, v1
    s_mul_i32 s23, s79, 12
    s_lshl_b32 s24, s76, 1
    s_add_u32 s23, s23, s24
    s_add_u32 s23, s23, s78
    s_mul_i32 s23, s23, 384
    s_add_u32 s23, s23, 15077376
    buffer_store_dword v144, v11, s[12:15], s23 offen sc1
    s_mov_b64 exec, 0xffffffff
    buffer_store_dword v146, v11, s[12:15], s23 offen offset:256 sc1
    s_mov_b64 exec, -1
    s_mul_i32 s62, s10, 24
    s_add_u32 s62, s62, s11
    s_lshl_b32 s62, s62, 2
    s_add_u32 s62, s62, 14705664
    s_lshl_b32 s23, s79, 7
    s_add_u32 s23, s23, 15372288
    v_mov_b32 v10, 155656
    v_mov_b32 v11, 1
    s_mov_b64 exec, 1
    ds_add_u32 v10, v11
    s_mov_b64 exec, -1
    s_mul_i32 s24, s79, 36864
    s_lshl_b32 s35, s63, 5
    s_add_u32 s24, s24, s35
    s_add_u32 s24, s24, 11534336
    buffer_store_dwordx4 v[72:75], v7, s[12:15], s24 offen offset:0 sc1
    buffer_store_dwordx4 v[76:79], v7, s[12:15], s24 offen offset:1024 sc1
    buffer_store_dwordx4 v[80:83], v7, s[12:15], s24 offen offset:2048 sc1
    s_mov_b64 exec, 1
    v_mov_b32 v8, 155692
    v_mov_b32 v9, 1
    s_waitcnt vmcnt(0)
    ds_add_rtn_u32 v10, v8, v9
    v_mov_b32 v8, 0
    s_waitcnt lgkmcnt(0)
    v_readfirstlane_b32 s35, v10
    s_nop 0
    s_cmp_lg_u32 s35, 3
    s_cbranch_scc1 k2_attn_kernel_nofh2
    buffer_store_dword v9, v8, s[12:15], s62 offen offset:2048 sc1
k2_attn_kernel_nofh2:
    s_mov_b64 exec, -1
    v_mov_b32 v8, 0
    s_cmp_lg_u32 s22, 0
    s_cbranch_scc1 k2_attn_kernel_gow
    s_lshl_b32 s24, s10, 7
    s_add_u32 s24, s24, 14706688
    s_mov_b32 s35, 0
k2_attn_kernel_gop:
    buffer_load_dwordx4 v[24:27], v8, s[12:15], s24 offen sc1
    s_add_u32 s35, s35, 1
    s_waitcnt vmcnt(0)
    v_readfirstlane_b32 s62, v24
    s_nop 0
    s_cmp_lg_u32 s62, 0
    s_cbranch_scc1 k2_attn_kernel_god
    s_sleep 1
    s_cmp_lt_u32 s35, 60000
    s_cbranch_scc1 k2_attn_kernel_gop
k2_attn_kernel_god:
    v_mov_b32 v9, 155696
    ds_write_b128 v9, v[24:27]
    s_waitcnt lgkmcnt(0)
    v_mov_b32 v10, 155660
    v_mov_b32 v11, 1
    s_mov_b64 exec, 1
    ds_add_u32 v10, v11
    s_mov_b64 exec, -1
k2_attn_kernel_gow:
    v_mov_b32 v10, 155660
    s_mov_b32 s35, 0
k2_attn_kernel_lw3:
    ds_read_b32 v11, v10
    s_add_u32 s35, s35, 1
    s_waitcnt lgkmcnt(0)
    v_readfirstlane_b32 s24, v11
    s_nop 0
    s_cmp_ge_u32 s24, 1
    s_cbranch_scc1 k2_attn_kernel_lwd3
    s_sleep 1
    s_cmp_lt_u32 s35, 0x800000
    s_cbranch_scc1 k2_attn_kernel_lw3
k2_attn_kernel_lwd3:
    v_mov_b32 v9, 155696
    ds_read_b128 v[24:27], v9
    v_lshlrev_b32 v11, 2, v2
    s_add_u32 s24, s23, 8192
    buffer_load_dword v28, v11, s[12:15], s23 offen sc1
    buffer_load_dword v29, v11, s[12:15], s24 offen sc1
    s_waitcnt lgkmcnt(0)
    v_readfirstlane_b32 s62, v24
    s_nop 0
    s_sub_u32 s62, s62, 1
    s_lshl_b32 s35, s79, 5
    s_sub_u32 s35, s62, s35
    s_cmp_ge_u32 s35, 32
    s_cbranch_scc1 k2_attn_kernel_notown
    v_cmp_eq_u32 vcc, s35, v2
    s_nop 1
    v_cndmask_b32 v5, v5, -1, vcc
    v_and_b32 v5, 0x7ffffff8, v5
k2_attn_kernel_notown:
    s_mov_b32 s35, 0
k2_attn_kernel_fs:
    s_waitcnt vmcnt(0)
    v_max_u32 v30, v28, v29
    v_cmp_eq_u32 vcc, -1, v30
    s_cbranch_vccz k2_attn_kernel_fsd
    v_lshlrev_b32 v11, 2, v2
    buffer_load_dword v28, v11, s[12:15], s23 offen sc1
    buffer_load_dword v29, v11, s[12:15], s24 offen sc1
    s_add_u32 s35, s35, 1
    s_cmp_lt_u32 s35, 20000
    s_cbranch_scc1 k2_attn_kernel_fs
    s_waitcnt vmcnt(0)
k2_attn_kernel_fsd:
    v_mul_f32 v30, 0x3ae38e39, v28
    v_mul_f32 v32, 0x3ae38e39, v29
    v_fma_f32 v32, -v30, v30, v32
    v_max_f32 v32, 0, v32
    v_cvt_pk_bf16_f32 v32, v32, v32
    v_lshlrev_b32 v32, 16, v32
    v_add_f32 v32, 0x3727c5ac, v32
    v_cvt_pk_bf16_f32 v32, v32, v32
    v_lshlrev_b32 v32, 16, v32
    v_sqrt_f32 v32, v32
    s_nop 0
    v_cvt_pk_bf16_f32 v32, v32, v32
    v_lshlrev_b32 v32, 16, v32
    v_rcp_f32 v31, v32
    v_cvt_pk_bf16_f32 v30, v30, v30
    v_lshlrev_b32 v30, 16, v30
    v_lshlrev_b32 v8, 16, v72
    v_and_b32 v9, 0xffff0000, v72
    v_sub_f32 v10, v8, v30
    v_sub_f32 v11, v9, v30
    v_cvt_pk_bf16_f32 v33, v10, v11
    v_lshlrev_b32 v10, 16, v33
    v_and_b32 v11, 0xffff0000, v33
    v_mul_f32 v10, v10, v31
    v_mul_f32 v11, v11, v31
    v_cvt_pk_bf16_f32 v33, v10, v11
    v_lshlrev_b32 v10, 16, v33
    v_and_b32 v11, 0xffff0000, v33
    v_add_f32 v10, v10, v8
    v_add_f32 v11, v11, v9
    v_cvt_pk_bf16_f32 v108, v10, v11
    v_lshlrev_b32 v8, 16, v73
    v_and_b32 v9, 0xffff0000, v73
    v_sub_f32 v10, v8, v30
    v_sub_f32 v11, v9, v30
    v_cvt_pk_bf16_f32 v33, v10, v11
    v_lshlrev_b32 v10, 16, v33
    v_and_b32 v11, 0xffff0000, v33
    v_mul_f32 v10, v10, v31
    v_mul_f32 v11, v11, v31
    v_cvt_pk_bf16_f32 v33, v10, v11
    v_lshlrev_b32 v10, 16, v33
    v_and_b32 v11, 0xffff0000, v33
    v_add_f32 v10, v10, v8
    v_add_f32 v11, v11, v9
    v_cvt_pk_bf16_f32 v109, v10, v11
    buffer_store_dwordx2 v[108:109], v5, s[16:19], s34 offen offset:0
    v_lshlrev_b32 v8, 16, v74
    v_and_b32 v9, 0xffff0000, v74
    v_sub_f32 v10, v8, v30
    v_sub_f32 v11, v9, v30
    v_cvt_pk_bf16_f32 v33, v10, v11
    v_lshlrev_b32 v10, 16, v33
    v_and_b32 v11, 0xffff0000, v33
    v_mul_f32 v10, v10, v31
    v_mul_f32 v11, v11, v31
    v_cvt_pk_bf16_f32 v33, v10, v11
    v_lshlrev_b32 v10, 16, v33
    v_and_b32 v11, 0xffff0000, v33
    v_add_f32 v10, v10, v8
    v_add_f32 v11, v11, v9
    v_cvt_pk_bf16_f32 v110, v10, v11
    v_lshlrev_b32 v8, 16, v75
    v_and_b32 v9, 0xffff0000, v75
    v_sub_f32 v10, v8, v30
    v_sub_f32 v11, v9, v30
    v_cvt_pk_bf16_f32 v33, v10, v11
    v_lshlrev_b32 v10, 16, v33
    v_and_b32 v11, 0xffff0000, v33
    v_mul_f32 v10, v10, v31
    v_mul_f32 v11, v11, v31
    v_cvt_pk_bf16_f32 v33, v10, v11
    v_lshlrev_b32 v10, 16, v33
    v_and_b32 v11, 0xffff0000, v33
    v_add_f32 v10, v10, v8
    v_add_f32 v11, v11, v9
    v_cvt_pk_bf16_f32 v111, v10, v11
    buffer_store_dwordx2 v[110:111], v5, s[16:19], s34 offen offset:16
    v_lshlrev_b32 v8, 16, v76
    v_and_b32 v9, 0xffff0000, v76
    v_sub_f32 v10, v8, v30
    v_sub_f32 v11, v9, v30
    v_cvt_pk_bf16_f32 v33, v10, v11
    v_lshlrev_b32 v10, 16, v33
    v_and_b32 v11, 0xffff0000, v33
    v_mul_f32 v10, v10, v31
    v_mul_f32 v11, v11, v31
    v_cvt_pk_bf16_f32 v33, v10, v11
    v_lshlrev_b32 v10, 16, v33
    v_and_b32 v11, 0xffff0000, v33
    v_add_f32 v10, v10, v8
    v_add_f32 v11, v11, v9
    v_cvt_pk_bf16_f32 v112, v10, v11
    v_lshlrev_b32 v8, 16, v77
    v_and_b32 v9, 0xffff0000, v77
    v_sub_f32 v10, v8, v30
    v_sub_f32 v11, v9, v30
    v_cvt_pk_bf16_f32 v33, v10, v11
    v_lshlrev_b32 v10, 16, v33
    v_and_b32 v11, 0xffff0000, v33
    v_mul_f32 v10, v10, v31
    v_mul_f32 v11, v11, v31
    v_cvt_pk_bf16_f32 v33, v10, v11
    v_lshlrev_b32 v10, 16, v33
    v_and_b32 v11, 0xffff0000, v33
    v_add_f32 v10, v10, v8
    v_add_f32 v11, v11, v9
    v_cvt_pk_bf16_f32 v113, v10, v11
    buffer_store_dwordx2 v[112:113], v5, s[16:19], s34 offen offset:32
    v_lshlrev_b32 v8, 16, v78
    v_and_b32 v9, 0xffff0000, v78
    v_sub_f32 v10, v8, v30
    v_sub_f32 v11, v9, v30
    v_cvt_pk_bf16_f32 v33, v10, v11
    v_lshlrev_b32 v10, 16, v33
    v_and_b32 v11, 0xffff0000, v33
    v_mul_f32 v10, v10, v31
    v_mul_f32 v11, v11, v31
    v_cvt_pk_bf16_f32 v33, v10, v11
    v_lshlrev_b32 v10, 16, v33
    v_and_b32 v11, 0xffff0000, v33
    v_add_f32 v10, v10, v8
    v_add_f32 v11, v11, v9
    v_cvt_pk_bf16_f32 v114, v10, v11
    v_lshlrev_b32 v8, 16, v79
    v_and_b32 v9, 0xffff0000, v79
    v_sub_f32 v10, v8, v30
    v_sub_f32 v11, v9, v30
    v_cvt_pk_bf16_f32 v33, v10, v11
    v_lshlrev_b32 v10, 16, v33
    v_and_b32 v11, 0xffff0000, v33
    v_mul_f32 v10, v10, v31
    v_mul_f32 v11, v11, v31
    v_cvt_pk_bf16_f32 v33, v10, v11
    v_lshlrev_b32 v10, 16, v33
    v_and_b32 v11, 0xffff0000, v33
    v_add_f32 v10, v10, v8
    v_add_f32 v11, v11, v9
    v_cvt_pk_bf16_f32 v115, v10, v11
    buffer_store_dwordx2 v[114:115], v5, s[16:19], s34 offen offset:48
    v_lshlrev_b32 v8, 16, v80
    v_and_b32 v9, 0xffff0000, v80
    v_sub_f32 v10, v8, v30
    v_sub_f32 v11, v9, v30
    v_cvt_pk_bf16_f32 v33, v10, v11
    v_lshlrev_b32 v10, 16, v33
    v_and_b32 v11, 0xffff0000, v33
    v_mul_f32 v10, v10, v31
    v_mul_f32 v11, v11, v31
    v_cvt_pk_bf16_f32 v33, v10, v11
    v_lshlrev_b32 v10, 16, v33
    v_and_b32 v11, 0xffff0000, v33
    v_add_f32 v10, v10, v8
    v_add_f32 v11, v11, v9
    v_cvt_pk_bf16_f32 v116, v10, v11
    v_lshlrev_b32 v8, 16, v81
    v_and_b32 v9, 0xffff0000, v81
    v_sub_f32 v10, v8, v30
    v_sub_f32 v11, v9, v30
    v_cvt_pk_bf16_f32 v33, v10, v11
    v_lshlrev_b32 v10, 16, v33
    v_and_b32 v11, 0xffff0000, v33
    v_mul_f32 v10, v10, v31
    v_mul_f32 v11, v11, v31
    v_cvt_pk_bf16_f32 v33, v10, v11
    v_lshlrev_b32 v10, 16, v33
    v_and_b32 v11, 0xffff0000, v33
    v_add_f32 v10, v10, v8
    v_add_f32 v11, v11, v9
    v_cvt_pk_bf16_f32 v117, v10, v11
    buffer_store_dwordx2 v[116:117], v5, s[16:19], s34 offen offset:64
    v_lshlrev_b32 v8, 16, v82
    v_and_b32 v9, 0xffff0000, v82
    v_sub_f32 v10, v8, v30
    v_sub_f32 v11, v9, v30
    v_cvt_pk_bf16_f32 v33, v10, v11
    v_lshlrev_b32 v10, 16, v33
    v_and_b32 v11, 0xffff0000, v33
    v_mul_f32 v10, v10, v31
    v_mul_f32 v11, v11, v31
    v_cvt_pk_bf16_f32 v33, v10, v11
    v_lshlrev_b32 v10, 16, v33
    v_and_b32 v11, 0xffff0000, v33
    v_add_f32 v10, v10, v8
    v_add_f32 v11, v11, v9
    v_cvt_pk_bf16_f32 v118, v10, v11
    v_lshlrev_b32 v8, 16, v83
    v_and_b32 v9, 0xffff0000, v83
    v_sub_f32 v10, v8, v30
    v_sub_f32 v11, v9, v30
    v_cvt_pk_bf16_f32 v33, v10, v11
    v_lshlrev_b32 v10, 16, v33
    v_and_b32 v11, 0xffff0000, v33
    v_mul_f32 v10, v10, v31
    v_mul_f32 v11, v11, v31
    v_cvt_pk_bf16_f32 v33, v10, v11
    v_lshlrev_b32 v10, 16, v33
    v_and_b32 v11, 0xffff0000, v33
    v_add_f32 v10, v10, v8
    v_add_f32 v11, v11, v9
    v_cvt_pk_bf16_f32 v119, v10, v11
    buffer_store_dwordx2 v[118:119], v5, s[16:19], s34 offen offset:80
    s_endpgm
k2_attn_kernel_aux:
    s_sub_u32 s20, s22, 4
    v_subrev_u32 v4, 256, v0
    s_cmp_lt_u32 s11, 10
    s_cbranch_scc1 k2_attn_kernel_ffn
    s_cmp_ge_u32 s11, 24
    s_cbranch_scc1 k2_attn_kernel_ffn
    s_cmp_eq_u32 s2, 191
    s_cbranch_scc1 k2_attn_kernel_agg
    s_lshr_b32 s23, s11, 2
    s_cmp_eq_u32 s23, 4
    s_cbranch_scc1 k2_attn_kernel_l1
    s_sub_u32 s31, s11, 10
    s_lshl_b32 s31, s31, 3
    s_add_u32 s31, s31, s10
    s_cmp_ge_u32 s31, 18
    s_cbranch_scc1 k2_attn_kernel_end
    v_lshrrev_b32 v8, 5, v4
    v_mul_u32_u24 v8, 20736, v8
    v_lshl_add_u32 v16, v2, 2, v8
    s_lshl_b32 s28, s31, 7
    s_add_u32 s28, s28, 14745600
    v_mov_b32 v10, 155660
    s_mov_b32 s23, 0
k2_attn_kernel_lw4:
    ds_read_b32 v11, v10
    s_add_u32 s23, s23, 1
    s_waitcnt lgkmcnt(0)
    v_readfirstlane_b32 s24, v11
    s_nop 0
    s_cmp_ge_u32 s24, 1
    s_cbranch_scc1 k2_attn_kernel_lwd4
    s_sleep 1
    s_cmp_lt_u32 s23, 0x800000
    s_cbranch_scc1 k2_attn_kernel_lw4
k2_attn_kernel_lwd4:
    v_mov_b32 v10, 155696
    ds_read_b128 v[24:27], v10
    v_lshlrev_b32 v17, 1, v2
    s_waitcnt lgkmcnt(0)
    v_readfirstlane_b32 s25, v24
    s_nop 0
    s_sub_u32 s25, s25, 1
    s_and_b32 s25, s25, 0x7ff
    s_lshr_b32 s24, s25, 5
    s_mul_i32 s24, s24, 36864
    s_and_b32 s23, s25, 31
    s_lshl_b32 s23, s23, 4
    s_add_u32 s24, s24, s23
    s_lshl_b32 s23, s31, 11
    s_add_u32 s24, s24, s23
    s_add_u32 s24, s24, 11534336
    v_lshrrev_b32 v18, 4, v2
    v_lshlrev_b32 v18, 10, v18
    v_bfe_u32 v19, v2, 2, 1
    v_lshl_add_u32 v18, v19, 9, v18
    v_bfe_u32 v19, v2, 3, 1
    v_lshl_add_u32 v18, v19, 3, v18
    v_and_b32 v19, 3, v2
    v_lshl_add_u32 v18, v19, 1, v18
    buffer_load_ushort v45, v18, s[12:15], s24 offen sc1
    s_mul_i32 s25, s25, 1152
    s_lshl_b32 s23, s31, 6
    s_add_u32 s25, s25, s23
    v_cvt_pk_bf16_f32 v27, v27, v27
    v_lshlrev_b32 v27, 16, v27
    v_mul_f32 v28, 0xbfb8aa3b, v27
    v_exp_f32 v28, v28
    s_nop 0
    v_add_f32 v28, 1.0, v28
    v_rcp_f32 v28, v28
    s_nop 0
    v_cvt_pk_bf16_f32 v28, v28, v28
    v_lshlrev_b32 v28, 16, v28
    s_waitcnt vmcnt(0)
    v_lshlrev_b32 v8, 16, v45
    v_and_b32 v9, 0xffff0000, v45
    v_sub_f32 v10, v8, v25
    v_sub_f32 v11, v9, v25
    v_cvt_pk_bf16_f32 v44, v10, v11
    v_lshlrev_b32 v10, 16, v44
    v_and_b32 v11, 0xffff0000, v44
    v_mul_f32 v10, v10, v26
    v_mul_f32 v11, v11, v26
    v_cvt_pk_bf16_f32 v44, v10, v11
    v_lshlrev_b32 v44, 16, v44
    v_lshlrev_b32 v45, 16, v45
    s_mov_b32 s24, 0
k2_attn_kernel_rpoll:
    s_mov_b32 s34, s28
    buffer_load_dword v32, v16, s[12:15], s34 offen sc1
    s_add_u32 s34, s34, 2304
    buffer_load_dword v33, v16, s[12:15], s34 offen sc1
    s_add_u32 s34, s34, 2304
    buffer_load_dword v34, v16, s[12:15], s34 offen sc1
    s_add_u32 s34, s34, 2304
    buffer_load_dword v35, v16, s[12:15], s34 offen sc1
    s_add_u32 s34, s34, 2304
    buffer_load_dword v36, v16, s[12:15], s34 offen sc1
    s_add_u32 s34, s34, 2304
    buffer_load_dword v37, v16, s[12:15], s34 offen sc1
    s_add_u32 s34, s34, 2304
    buffer_load_dword v38, v16, s[12:15], s34 offen sc1
    s_add_u32 s34, s34, 2304
    buffer_load_dword v39, v16, s[12:15], s34 offen sc1
    s_add_u32 s34, s34, 2304
    buffer_load_dword v40, v16, s[12:15], s34 offen sc1
    s_add_u32 s34, s34, 2304
    s_add_u32 s24, s24, 1
    s_waitcnt vmcnt(0)
    v_max3_u32 v41, v32, v33, v34
    v_max3_u32 v42, v35, v36, v37
    v_max3_u32 v43, v38, v39, v40
    v_max3_u32 v41, v41, v42, v43
    v_cmp_eq_u32 vcc, -1, v41
    s_cmp_gt_u32 s24, 40000
    s_cbranch_scc1 k2_attn_kernel_rgo
    s_cbranch_vccnz k2_attn_kernel_rpoll
k2_attn_kernel_rgo:
    v_add_f32 v32, v32, v33
    v_add_f32 v32, v32, v34
    v_add_f32 v32, v32, v35
    v_add_f32 v32, v32, v36
    v_add_f32 v32, v32, v37
    v_add_f32 v32, v32, v38
    v_add_f32 v32, v32, v39
    v_add_f32 v32, v32, v40
    v_mov_b32 v33, v32
    s_nop 1
    v_permlane32_swap_b32 v32, v33
    v_add_f32 v32, v32, v33
    v_lshlrev_b32 v9, 2, v4
    v_add_u32 v9, 157760, v9
    ds_write_b32 v9, v32
    s_waitcnt lgkmcnt(0)
    v_mov_b32 v10, 155688
    v_mov_b32 v11, 1
    s_mov_b64 exec, 1
    ds_add_u32 v10, v11
    s_mov_b64 exec, -1
    s_cmp_lg_u32 s20, 0
    s_cbranch_scc1 k2_attn_kernel_end
    v_mov_b32 v10, 155688
    s_mov_b32 s34, 0
k2_attn_kernel_lw5:
    ds_read_b32 v11, v10
    s_add_u32 s34, s34, 1
    s_waitcnt lgkmcnt(0)
    v_readfirstlane_b32 s24, v11
    s_nop 0
    s_cmp_ge_u32 s24, 8
    s_cbranch_scc1 k2_attn_kernel_lwd5
    s_nop 0
    s_cmp_lt_u32 s34, 0x800000
    s_cbranch_scc1 k2_attn_kernel_lw5
k2_attn_kernel_lwd5:
    v_lshlrev_b32 v9, 2, v2
    v_add_u32 v9, 157760, v9
    ds_read_b32 v32, v9 offset:0
    ds_read_b32 v33, v9 offset:256
    ds_read_b32 v34, v9 offset:512
    ds_read_b32 v35, v9 offset:768
    ds_read_b32 v36, v9 offset:1024
    ds_read_b32 v37, v9 offset:1280
    ds_read_b32 v38, v9 offset:1536
    ds_read_b32 v39, v9 offset:1792
    s_waitcnt lgkmcnt(0)
    v_add_f32 v32, v32, v33
    v_add_f32 v32, v32, v34
    v_add_f32 v32, v32, v35
    v_add_f32 v32, v32, v36
    v_add_f32 v32, v32, v37
    v_add_f32 v32, v32, v38
    v_add_f32 v32, v32, v39
    v_cvt_pk_bf16_f32 v32, v32, v32
    v_lshlrev_b32 v32, 16, v32
    v_mul_f32 v32, v32, v28
    v_cvt_pk_bf16_f32 v32, v32, v32
    v_lshlrev_b32 v32, 16, v32
    v_add_f32 v29, v44, v32
    v_cvt_pk_bf16_f32 v29, v29, v29
    v_lshlrev_b32 v29, 16, v29
    v_add_f32 v29, v29, v45
    v_cvt_pk_bf16_f32 v29, v29, v29
    s_mov_b64 exec, 0xffffffff
    buffer_store_short v29, v17, s[16:19], s25 offen
    s_mov_b64 exec, -1
    s_endpgm
k2_attn_kernel_l1:
    s_cmp_gt_u32 s20, 1
    s_cbranch_scc1 k2_attn_kernel_end
    v_lshlrev_b32 v9, 2, v1
    buffer_load_dword v36, v9, s[68:71], 0 offen offset:0
    buffer_load_dword v37, v9, s[68:71], 0 offen offset:256
    buffer_load_dword v38, v9, s[68:71], 0 offen offset:512
    buffer_load_dword v39, v9, s[68:71], 0 offen offset:768
    buffer_load_dword v40, v9, s[68:71], 0 offen offset:1024
    v_mov_b32 v16, 0
    v_mov_b32 v11, 0x3f803f80
    s_waitcnt vmcnt(0)
    v_dot2c_f32_bf16 v16, v36, v11
    v_dot2c_f32_bf16 v16, v37, v11
    v_dot2c_f32_bf16 v16, v38, v11
    v_dot2c_f32_bf16 v16, v39, v11
    v_dot2c_f32_bf16 v16, v40, v11
    s_nop 2
    v_add_f32_dpp v16, v16, v16 row_shr:1 row_mask:0xf bank_mask:0xf bound_ctrl:0
    s_nop 1
    v_add_f32_dpp v16, v16, v16 row_shr:2 row_mask:0xf bank_mask:0xf bound_ctrl:0
    s_nop 1
    v_add_f32_dpp v16, v16, v16 row_shr:4 row_mask:0xf bank_mask:0xf bound_ctrl:0
    s_nop 1
    v_add_f32_dpp v16, v16, v16 row_shr:8 row_mask:0xf bank_mask:0xf bound_ctrl:0
    s_nop 1
    v_add_f32_dpp v16, v16, v16 row_bcast:15 row_mask:0xa bank_mask:0xf
    s_nop 1
    v_add_f32_dpp v16, v16, v16 row_bcast:31 row_mask:0xc bank_mask:0xf
    s_nop 0
    v_readlane_b32 s27, v16, 63
    s_and_b32 s31, s11, 3
    s_lshl_b32 s23, s10, 2
    s_add_u32 s31, s31, s23
    s_lshl_b32 s31, s31, 1
    s_add_u32 s31, s31, s20
    s_mul_i32 s28, s31, 4608
    s_add_u32 s28, s28, 15077376
    v_mul_u32_u24 v17, 2304, v3
    v_lshl_add_u32 v17, v2, 2, v17
    s_mov_b32 s24, 0
k2_attn_kernel_l1p:
    buffer_load_dword v24, v17, s[12:15], s28 offen offset:0 sc1
    buffer_load_dword v25, v17, s[12:15], s28 offen offset:128 sc1
    buffer_load_dword v26, v17, s[12:15], s28 offen offset:256 sc1
    buffer_load_dword v27, v17, s[12:15], s28 offen offset:384 sc1
    buffer_load_dword v28, v17, s[12:15], s28 offen offset:512 sc1
    buffer_load_dword v29, v17, s[12:15], s28 offen offset:640 sc1
    buffer_load_dword v30, v17, s[12:15], s28 offen offset:768 sc1
    buffer_load_dword v31, v17, s[12:15], s28 offen offset:896 sc1
    buffer_load_dword v32, v17, s[12:15], s28 offen offset:1024 sc1
    buffer_load_dword v33, v17, s[12:15], s28 offen offset:1152 sc1
    buffer_load_dword v34, v17, s[12:15], s28 offen offset:1280 sc1
    buffer_load_dword v35, v17, s[12:15], s28 offen offset:1408 sc1
    buffer_load_dword v36, v17, s[12:15], s28 offen offset:1536 sc1
    buffer_load_dword v37, v17, s[12:15], s28 offen offset:1664 sc1
    buffer_load_dword v38, v17, s[12:15], s28 offen offset:1792 sc1
    buffer_load_dword v39, v17, s[12:15], s28 offen offset:1920 sc1
    buffer_load_dword v40, v17, s[12:15], s28 offen offset:2048 sc1
    buffer_load_dword v41, v17, s[12:15], s28 offen offset:2176 sc1
    s_add_u32 s24, s24, 1
    s_waitcnt vmcnt(0)
    v_max3_u32 v44, v24, v25, v26
    v_max3_u32 v44, v44, v27, v28
    v_max3_u32 v44, v44, v29, v30
    v_max3_u32 v44, v44, v31, v32
    v_max3_u32 v44, v44, v33, v34
    v_max3_u32 v44, v44, v35, v36
    v_max3_u32 v44, v44, v37, v38
    v_max3_u32 v44, v44, v39, v40
    v_max_u32 v44, v44, v41
    v_cmp_eq_u32 vcc, -1, v44
    s_cmp_gt_u32 s24, 40000
    s_cbranch_scc1 k2_attn_kernel_l1d
    s_cbranch_vccnz k2_attn_kernel_l1p
k2_attn_kernel_l1d:
    v_add_f32 v24, v24, v27
    v_add_f32 v25, v25, v28
    v_add_f32 v26, v26, v29
    v_add_f32 v24, v24, v30
    v_add_f32 v25, v25, v31
    v_add_f32 v26, v26, v32
    v_add_f32 v24, v24, v33
    v_add_f32 v25, v25, v34
    v_add_f32 v26, v26, v35
    v_add_f32 v24, v24, v36
    v_add_f32 v25, v25, v37
    v_add_f32 v26, v26, v38
    v_add_f32 v24, v24, v39
    v_add_f32 v25, v25, v40
    v_add_f32 v26, v26, v41
    v_mov_b32 v45, v24
    v_mov_b32 v46, v25
    v_mov_b32 v47, v26
    v_permlane32_swap_b32 v24, v45
    v_permlane32_swap_b32 v25, v46
    v_permlane32_swap_b32 v26, v47
    v_add_f32 v49, v24, v45
    v_add_f32 v50, v25, v46
    v_add_f32 v51, v26, v47
    v_cmp_eq_u32 vcc, 0, v3
    s_nop 1
    v_cndmask_b32 v44, v50, v49, vcc
    v_lshlrev_b32 v45, 13, v3
    v_lshl_add_u32 v45, v2, 2, v45
    s_lshl_b32 s23, s31, 7
    s_add_u32 s23, s23, 15372288
    buffer_store_dword v44, v45, s[12:15], s23 offen sc1
    v_mul_f32 v8, 0x3ae38e39, v49
    v_mul_f32 v9, 0x3ae38e39, v50
    v_fma_f32 v9, -v8, v8, v9
    v_max_f32 v9, 0, v9
    v_add_f32 v9, 0x3727c5ac, v9
    v_rsq_f32 v9, v9
    v_fma_f32 v8, -v8, s27, v51
    v_mul_f32 v8, v8, v9
    v_ashrrev_i32 v9, 31, v8
    v_or_b32 v9, 0x80000000, v9
    v_xor_b32 v8, v8, v9
    v_min_u32 v8, 0xfffff000, v8
    v_and_b32 v8, 0xfffff800, v8
    s_lshl_b32 s23, s31, 5
    s_sub_u32 s23, 2047, s23
    v_sub_u32 v9, s23, v2
    v_or_b32 v48, v8, v9
    v_mov_b32 v44, v48
    s_nop 1
    v_max_u32_dpp v44, v44, v44 row_shr:1 row_mask:0xf bank_mask:0xf bound_ctrl:0
    s_nop 1
    v_max_u32_dpp v44, v44, v44 row_shr:2 row_mask:0xf bank_mask:0xf bound_ctrl:0
    s_nop 1
    v_max_u32_dpp v44, v44, v44 row_shr:4 row_mask:0xf bank_mask:0xf bound_ctrl:0
    s_nop 1
    v_max_u32_dpp v44, v44, v44 row_shr:8 row_mask:0xf bank_mask:0xf bound_ctrl:0
    s_nop 1
    v_max_u32_dpp v44, v44, v44 row_bcast:15 row_mask:0xa bank_mask:0xf
    s_nop 1
    v_max_u32_dpp v44, v44, v44 row_bcast:31 row_mask:0xc bank_mask:0xf
    s_nop 0
    v_readlane_b32 s23, v44, 63
    v_mov_b32 v8, 0
    s_lshl_b32 s24, s31, 4
    s_add_u32 s24, s24, 15388672
    v_cmp_eq_u32 vcc, s23, v48
    s_and_b32 exec_lo, vcc_lo, -1
    s_mov_b32 exec_hi, 0
    buffer_store_dwordx4 v[48:51], v8, s[12:15], s24 offen sc1
    s_mov_b64 exec, -1
    s_endpgm
k2_attn_kernel_agg:
    s_cmp_gt_u32 s20, 0
    s_cbranch_scc1 k2_attn_kernel_end
    v_lshlrev_b32 v9, 2, v1
    buffer_load_dword v36, v9, s[68:71], 0 offen offset:0
    buffer_load_dword v37, v9, s[68:71], 0 offen offset:256
    buffer_load_dword v38, v9, s[68:71], 0 offen offset:512
    buffer_load_dword v39, v9, s[68:71], 0 offen offset:768
    buffer_load_dword v40, v9, s[68:71], 0 offen offset:1024
    v_mov_b32 v16, 0
    v_mov_b32 v11, 0x3f803f80
    s_waitcnt vmcnt(0)
    v_dot2c_f32_bf16 v16, v36, v11
    v_dot2c_f32_bf16 v16, v37, v11
    v_dot2c_f32_bf16 v16, v38, v11
    v_dot2c_f32_bf16 v16, v39, v11
    v_dot2c_f32_bf16 v16, v40, v11
    s_nop 2
    v_add_f32_dpp v16, v16, v16 row_shr:1 row_mask:0xf bank_mask:0xf bound_ctrl:0
    s_nop 1
    v_add_f32_dpp v16, v16, v16 row_shr:2 row_mask:0xf bank_mask:0xf bound_ctrl:0
    s_nop 1
    v_add_f32_dpp v16, v16, v16 row_shr:4 row_mask:0xf bank_mask:0xf bound_ctrl:0
    s_nop 1
    v_add_f32_dpp v16, v16, v16 row_shr:8 row_mask:0xf bank_mask:0xf bound_ctrl:0
    s_nop 1
    v_add_f32_dpp v16, v16, v16 row_bcast:15 row_mask:0xa bank_mask:0xf
    s_nop 1
    v_add_f32_dpp v16, v16, v16 row_bcast:31 row_mask:0xc bank_mask:0xf
    s_nop 0
    v_readlane_b32 s27, v16, 63
    s_mov_b32 s34, 15388672
    s_mov_b32 s28, 14707712
    v_min_u32 v17, 47, v1
    v_lshlrev_b32 v17, 4, v17
    s_mov_b32 s24, 0
k2_attn_kernel_agp:
    buffer_load_dwordx4 v[24:27], v7, s[12:15], s34 offen sc1
    buffer_load_dwordx4 v[52:55], v17, s[12:15], s28 offen sc1
    s_add_u32 s24, s24, 1
    s_waitcnt vmcnt(0)
    v_max3_u32 v28, v24, v25, v26
    v_max_u32 v28, v28, v27
    v_and_b32 v52, v52, v53
    v_and_b32 v54, v54, v55
    v_and_b32 v52, v52, v54
    v_cmp_eq_u32 vcc, -1, v28
    v_cmp_ne_u32 s[72:73], 1, v52
    s_cmp_gt_u32 s24, 50000
    s_cbranch_scc1 k2_attn_kernel_agd
    s_or_b64 vcc, vcc, s[72:73]
    s_cbranch_scc1 k2_attn_kernel_agp
k2_attn_kernel_agd:
    v_mov_b32 v28, v24
    s_nop 1
    v_max_u32_dpp v28, v28, v28 row_shr:1 row_mask:0xf bank_mask:0xf bound_ctrl:0
    s_nop 1
    v_max_u32_dpp v28, v28, v28 row_shr:2 row_mask:0xf bank_mask:0xf bound_ctrl:0
    s_nop 1
    v_max_u32_dpp v28, v28, v28 row_shr:4 row_mask:0xf bank_mask:0xf bound_ctrl:0
    s_nop 1
    v_max_u32_dpp v28, v28, v28 row_shr:8 row_mask:0xf bank_mask:0xf bound_ctrl:0
    s_nop 1
    v_max_u32_dpp v28, v28, v28 row_bcast:15 row_mask:0xa bank_mask:0xf
    s_nop 1
    v_max_u32_dpp v28, v28, v28 row_bcast:31 row_mask:0xc bank_mask:0xf
    v_mul_f32 v49, 0x3ae38e39, v25
    v_mul_f32 v47, 0x3ae38e39, v26
    v_fma_f32 v47, -v49, v49, v47
    v_max_f32 v47, 0, v47
    v_cvt_pk_bf16_f32 v47, v47, v47
    v_lshlrev_b32 v47, 16, v47
    v_add_f32 v47, 0x3727c5ac, v47
    v_cvt_pk_bf16_f32 v47, v47, v47
    v_lshlrev_b32 v47, 16, v47
    v_sqrt_f32 v47, v47
    s_nop 0
    v_cvt_pk_bf16_f32 v47, v47, v47
    v_lshlrev_b32 v47, 16, v47
    v_rcp_f32 v50, v47
    v_cvt_pk_bf16_f32 v49, v49, v49
    v_lshlrev_b32 v49, 16, v49
    v_readlane_b32 s23, v28, 63
    v_and_b32 v48, 0x7ff, v24
    v_sub_u32 v48, 2048, v48
    v_fma_f32 v51, -v49, s27, v27
    v_mul_f32 v51, v51, v50
    v_cmp_eq_u32 s[72:73], s23, v24
    v_mov_b32 v8, 0
    s_mov_b32 s23, 14706688
    s_mov_b64 exec, s[72:73]
    buffer_store_dwordx4 v[48:51], v8, s[12:15], s23 offen offset:0 sc1
    buffer_store_dwordx4 v[48:51], v8, s[12:15], s23 offen offset:128 sc1
    buffer_store_dwordx4 v[48:51], v8, s[12:15], s23 offen offset:256 sc1
    buffer_store_dwordx4 v[48:51], v8, s[12:15], s23 offen offset:384 sc1
    buffer_store_dwordx4 v[48:51], v8, s[12:15], s23 offen offset:512 sc1
    buffer_store_dwordx4 v[48:51], v8, s[12:15], s23 offen offset:640 sc1
    buffer_store_dwordx4 v[48:51], v8, s[12:15], s23 offen offset:768 sc1
    buffer_store_dwordx4 v[48:51], v8, s[12:15], s23 offen offset:896 sc1
    s_mov_b64 exec, -1
    s_endpgm
k2_attn_kernel_ffn:
    s_add_u32 s21, s11, 8
    s_and_b32 s21, s21, 31
    s_mul_i32 s23, s10, 18
    s_add_u32 s21, s21, s23
    s_cmp_lt_u32 s22, 8
    s_cbranch_scc1 k2_attn_kernel_fx
    s_mov_b32 s72, s21
    s_and_b32 s24, s22, 3
    s_lshl_b32 s74, s24, 10
    s_mul_i32 s75, s72, 36864
    s_add_u32 s75, s75, s74
    s_add_u32 m0, s74, 116736
    s_add_u32 s23, s75, 0
    buffer_load_dwordx4 v7, s[52:55], s23 offen lds
    s_add_u32 m0, s74, 120832
    s_add_u32 s23, s75, 4096
    buffer_load_dwordx4 v7, s[52:55], s23 offen lds
    s_add_u32 m0, s74, 124928
    s_add_u32 s23, s75, 8192
    buffer_load_dwordx4 v7, s[52:55], s23 offen lds
    s_add_u32 m0, s74, 129024
    s_add_u32 s23, s75, 12288
    buffer_load_dwordx4 v7, s[52:55], s23 offen lds
    s_add_u32 m0, s74, 133120
    s_add_u32 s23, s75, 16384
    buffer_load_dwordx4 v7, s[52:55], s23 offen lds
    s_add_u32 m0, s74, 137216
    s_add_u32 s23, s75, 20480
    buffer_load_dwordx4 v7, s[52:55], s23 offen lds
    s_add_u32 m0, s74, 141312
    s_add_u32 s23, s75, 24576
    buffer_load_dwordx4 v7, s[52:55], s23 offen lds
    s_add_u32 m0, s74, 145408
    s_add_u32 s23, s75, 28672
    buffer_load_dwordx4 v7, s[52:55], s23 offen lds
    s_add_u32 m0, s74, 149504
    s_add_u32 s23, s75, 32768
    buffer_load_dwordx4 v7, s[52:55], s23 offen lds
    s_cmp_ge_u32 s11, 24
    s_cbranch_scc1 k2_attn_kernel_fwd
    v_mov_b32 v10, 155656
    s_mov_b32 s23, 0
k2_attn_kernel_lw6:
    ds_read_b32 v11, v10
    s_add_u32 s23, s23, 1
    s_waitcnt lgkmcnt(0)
    v_readfirstlane_b32 s24, v11
    s_nop 0
    s_cmp_ge_u32 s24, 4
    s_cbranch_scc1 k2_attn_kernel_lwd6
    s_sleep 1
    s_cmp_lt_u32 s23, 0x800000
    s_cbranch_scc1 k2_attn_kernel_lw6
k2_attn_kernel_lwd6:
    s_and_b32 s24, s22, 3
    s_lshl_b32 s74, s24, 10
    v_lshrrev_b32 v8, 2, v1
    s_lshl_b32 s23, s24, 4
    v_add_u32 v8, s23, v8
    v_mul_u32_u24 v8, 9216, v8
    v_and_b32 v9, 3, v1
    v_lshl_add_u32 v23, v9, 4, v8
    s_lshl_b32 s73, s72, 6
    s_add_u32 m0, s74, 0
    s_add_u32 s23, s73, 0
    buffer_load_dwordx4 v23, s[44:47], s23 offen lds
    s_add_u32 m0, s74, 36864
    s_add_u32 s23, s73, 0
    buffer_load_dwordx4 v23, s[48:51], s23 offen lds
    s_add_u32 m0, s74, 4096
    s_add_u32 s23, s73, 589824
    buffer_load_dwordx4 v23, s[44:47], s23 offen lds
    s_add_u32 m0, s74, 40960
    s_add_u32 s23, s73, 589824
    buffer_load_dwordx4 v23, s[48:51], s23 offen lds
    s_add_u32 m0, s74, 8192
    s_add_u32 s23, s73, 1179648
    buffer_load_dwordx4 v23, s[44:47], s23 offen lds
    s_add_u32 m0, s74, 45056
    s_add_u32 s23, s73, 1179648
    buffer_load_dwordx4 v23, s[48:51], s23 offen lds
    s_add_u32 m0, s74, 12288
    s_add_u32 s23, s73, 1769472
    buffer_load_dwordx4 v23, s[44:47], s23 offen lds
    s_add_u32 m0, s74, 49152
    s_add_u32 s23, s73, 1769472
    buffer_load_dwordx4 v23, s[48:51], s23 offen lds
    s_add_u32 m0, s74, 16384
    s_add_u32 s23, s73, 2359296
    buffer_load_dwordx4 v23, s[44:47], s23 offen lds
    s_add_u32 m0, s74, 53248
    s_add_u32 s23, s73, 2359296
    buffer_load_dwordx4 v23, s[48:51], s23 offen lds
    s_add_u32 m0, s74, 20480
    s_add_u32 s23, s73, 2949120
    buffer_load_dwordx4 v23, s[44:47], s23 offen lds
    s_add_u32 m0, s74, 57344
    s_add_u32 s23, s73, 2949120
    buffer_load_dwordx4 v23, s[48:51], s23 offen lds
    s_add_u32 m0, s74, 24576
    s_add_u32 s23, s73, 3538944
    buffer_load_dwordx4 v23, s[44:47], s23 offen lds
    s_add_u32 m0, s74, 61440
    s_add_u32 s23, s73, 3538944
    buffer_load_dwordx4 v23, s[48:51], s23 offen lds
    s_add_u32 m0, s74, 28672
    s_add_u32 s23, s73, 4128768
    buffer_load_dwordx4 v23, s[44:47], s23 offen lds
    s_add_u32 m0, s74, 65536
    s_add_u32 s23, s73, 4128768
    buffer_load_dwordx4 v23, s[48:51], s23 offen lds
    s_add_u32 m0, s74, 32768
    s_add_u32 s23, s73, 4718592
    buffer_load_dwordx4 v23, s[44:47], s23 offen lds
    s_add_u32 m0, s74, 69632
    s_add_u32 s23, s73, 4718592
    buffer_load_dwordx4 v23, s[48:51], s23 offen lds
k2_attn_kernel_fwd:
    s_waitcnt vmcnt(0)
    v_mov_b32 v10, 155664
    v_mov_b32 v11, 1
    s_mov_b64 exec, 1
    ds_add_u32 v10, v11
    s_mov_b64 exec, -1
    s_branch k2_attn_kernel_fgo
k2_attn_kernel_fx:
    s_cmp_gt_u32 s20, 1
    s_cbranch_scc1 k2_attn_kernel_fgo
    v_min_u32 v8, 71, v4
    v_lshrrev_b32 v9, 1, v8
    v_and_b32 v8, 1, v8
    v_lshlrev_b32 v22, 10, v9
    v_lshl_add_u32 v22, v8, 9, v22
    v_lshlrev_b32 v23, 5, v9
    v_lshl_add_u32 v23, v8, 3, v23
    v_add_u32 v23, 155712, v23
    v_mov_b32 v8, 0
    s_lshl_b32 s34, s10, 7
    s_add_u32 s34, s34, 14706688
    s_mov_b32 s24, 0
k2_attn_kernel_xp:
    buffer_load_dwordx4 v[24:27], v8, s[12:15], s34 offen sc1
    s_add_u32 s24, s24, 1
    s_waitcnt vmcnt(0)
    v_readfirstlane_b32 s23, v24
    s_nop 0
    s_cmp_lg_u32 s23, 0
    s_cbranch_scc1 k2_attn_kernel_xd
    s_cmp_lt_u32 s24, 60000
    s_cbranch_scc1 k2_attn_kernel_xp
k2_attn_kernel_xd:
    s_sub_u32 s23, s23, 1
    s_and_b32 s23, s23, 0x7ff
    s_lshr_b32 s24, s23, 5
    s_mul_i32 s24, s24, 36864
    s_and_b32 s23, s23, 31
    s_lshl_b32 s23, s23, 4
    s_add_u32 s23, s23, s24
    s_add_u32 s23, s23, 11534336
    buffer_load_dwordx4 v[28:31], v22, s[12:15], s23 offen sc1
k2_attn_kernel_fgo:
    s_lshr_b32 s23, s20, 1
    s_mul_i32 s24, s23, 288
    s_add_u32 s24, s24, 155712
    v_lshl_add_u32 v16, v3, 4, s24
    s_mul_i32 s23, s23, 9216
    s_and_b32 s24, s20, 1
    s_mul_i32 s24, s24, 36864
    s_add_u32 s23, s23, s24
    v_bfe_u32 v18, v1, 2, 2
    v_lshl_add_u32 v18, v3, 3, v18
    v_lshlrev_b32 v17, 6, v18
    v_bfe_u32 v19, v1, 4, 1
    v_lshl_add_u32 v17, v19, 5, v17
    v_and_b32 v20, 3, v1
    v_lshl_add_u32 v17, v20, 3, v17
    v_add_u32 v17, s23, v17
    v_mul_u32_u24 v21, 1152, v18
    v_lshl_add_u32 v21, v19, 5, v21
    v_lshl_add_u32 v21, v20, 3, v21
    s_lshl_b32 s23, s20, 6
    s_add_u32 s23, s23, 116736
    v_add_u32 v21, s23, v21
    v_mov_b32 v10, 155664
    s_mov_b32 s23, 0
k2_attn_kernel_lw7:
    ds_read_b32 v11, v10
    s_add_u32 s23, s23, 1
    s_waitcnt lgkmcnt(0)
    v_readfirstlane_b32 s24, v11
    s_nop 0
    s_cmp_ge_u32 s24, 4
    s_cbranch_scc1 k2_attn_kernel_lwd7
    s_sleep 1
    s_cmp_lt_u32 s23, 0x800000
    s_cbranch_scc1 k2_attn_kernel_lw7
k2_attn_kernel_lwd7:
    ds_read_b64_tr_b16 v[76:77], v17 offset:0
    ds_read_b64_tr_b16 v[78:79], v17 offset:256
    ds_read_b64_tr_b16 v[80:81], v17 offset:1024
    ds_read_b64_tr_b16 v[82:83], v17 offset:1280
    ds_read_b64_tr_b16 v[84:85], v17 offset:2048
    ds_read_b64_tr_b16 v[86:87], v17 offset:2304
    ds_read_b64_tr_b16 v[88:89], v17 offset:3072
    ds_read_b64_tr_b16 v[90:91], v17 offset:3328
    ds_read_b64_tr_b16 v[92:93], v17 offset:4096
    ds_read_b64_tr_b16 v[94:95], v17 offset:4352
    ds_read_b64_tr_b16 v[96:97], v17 offset:5120
    ds_read_b64_tr_b16 v[98:99], v17 offset:5376
    ds_read_b64_tr_b16 v[100:101], v17 offset:6144
    ds_read_b64_tr_b16 v[102:103], v17 offset:6400
    ds_read_b64_tr_b16 v[104:105], v17 offset:7168
    ds_read_b64_tr_b16 v[106:107], v17 offset:7424
    ds_read_b64_tr_b16 v[108:109], v17 offset:8192
    ds_read_b64_tr_b16 v[110:111], v17 offset:8448
    ds_read_b64_tr_b16 v[128:129], v21 offset:0
    ds_read_b64_tr_b16 v[130:131], v21 offset:4608
    ds_read_b64_tr_b16 v[132:133], v21 offset:18432
    ds_read_b64_tr_b16 v[134:135], v21 offset:23040
    ds_read_b64_tr_b16 v[136:137], v21 offset:512
    ds_read_b64_tr_b16 v[138:139], v21 offset:5120
    ds_read_b64_tr_b16 v[140:141], v21 offset:18944
    ds_read_b64_tr_b16 v[142:143], v21 offset:23552
    ds_read_b64_tr_b16 v[144:145], v21 offset:1024
    ds_read_b64_tr_b16 v[146:147], v21 offset:5632
    ds_read_b64_tr_b16 v[148:149], v21 offset:19456
    ds_read_b64_tr_b16 v[150:151], v21 offset:24064
    s_cmp_gt_u32 s20, 1
    s_cbranch_scc1 k2_attn_kernel_fx2
    s_waitcnt vmcnt(0)
    v_lshlrev_b32 v8, 16, v28
    v_and_b32 v9, 0xffff0000, v28
    v_sub_f32 v10, v8, v25
    v_sub_f32 v11, v9, v25
    v_cvt_pk_bf16_f32 v32, v10, v11
    v_lshlrev_b32 v10, 16, v32
    v_and_b32 v11, 0xffff0000, v32
    v_mul_f32 v10, v10, v26
    v_mul_f32 v11, v11, v26
    v_cvt_pk_bf16_f32 v32, v10, v11
    v_lshlrev_b32 v8, 16, v29
    v_and_b32 v9, 0xffff0000, v29
    v_sub_f32 v10, v8, v25
    v_sub_f32 v11, v9, v25
    v_cvt_pk_bf16_f32 v33, v10, v11
    v_lshlrev_b32 v10, 16, v33
    v_and_b32 v11, 0xffff0000, v33
    v_mul_f32 v10, v10, v26
    v_mul_f32 v11, v11, v26
    v_cvt_pk_bf16_f32 v33, v10, v11
    v_lshlrev_b32 v8, 16, v30
    v_and_b32 v9, 0xffff0000, v30
    v_sub_f32 v10, v8, v25
    v_sub_f32 v11, v9, v25
    v_cvt_pk_bf16_f32 v34, v10, v11
    v_lshlrev_b32 v10, 16, v34
    v_and_b32 v11, 0xffff0000, v34
    v_mul_f32 v10, v10, v26
    v_mul_f32 v11, v11, v26
    v_cvt_pk_bf16_f32 v34, v10, v11
    v_lshlrev_b32 v8, 16, v31
    v_and_b32 v9, 0xffff0000, v31
    v_sub_f32 v10, v8, v25
    v_sub_f32 v11, v9, v25
    v_cvt_pk_bf16_f32 v35, v10, v11
    v_lshlrev_b32 v10, 16, v35
    v_and_b32 v11, 0xffff0000, v35
    v_mul_f32 v10, v10, v26
    v_mul_f32 v11, v11, v26
    v_cvt_pk_bf16_f32 v35, v10, v11
    ds_write_b64 v23, v[32:33]
    ds_write_b64 v23, v[34:35] offset:16
    s_waitcnt lgkmcnt(0)
    v_mov_b32 v10, 155668
    v_mov_b32 v11, 1
    s_mov_b64 exec, 1
    ds_add_u32 v10, v11
    s_mov_b64 exec, -1
k2_attn_kernel_fx2:
    v_mov_b32 v10, 155668
    s_mov_b32 s23, 0
k2_attn_kernel_lw8:
    ds_read_b32 v11, v10
    s_add_u32 s23, s23, 1
    s_waitcnt lgkmcnt(0)
    v_readfirstlane_b32 s24, v11
    s_nop 0
    s_cmp_ge_u32 s24, 2
    s_cbranch_scc1 k2_attn_kernel_lwd8
    s_nop 0
    s_cmp_lt_u32 s23, 0x800000
    s_cbranch_scc1 k2_attn_kernel_lw8
k2_attn_kernel_lwd8:
    ds_read_b128 v[40:43], v16 offset:0
    ds_read_b128 v[44:47], v16 offset:32
    ds_read_b128 v[48:51], v16 offset:64
    ds_read_b128 v[52:55], v16 offset:96
    ds_read_b128 v[56:59], v16 offset:128
    ds_read_b128 v[60:63], v16 offset:160
    ds_read_b128 v[64:67], v16 offset:192
    ds_read_b128 v[68:71], v16 offset:224
    ds_read_b128 v[72:75], v16 offset:256
    s_waitcnt lgkmcnt(8)
    v_mfma_f32_32x32x16_bf16 v[112:127], v[40:43], v[76:79], 0
    s_waitcnt lgkmcnt(7)
    v_mfma_f32_32x32x16_bf16 v[112:127], v[44:47], v[80:83], v[112:127]
    s_waitcnt lgkmcnt(6)
    v_mfma_f32_32x32x16_bf16 v[112:127], v[48:51], v[84:87], v[112:127]
    s_waitcnt lgkmcnt(5)
    v_mfma_f32_32x32x16_bf16 v[112:127], v[52:55], v[88:91], v[112:127]
    s_waitcnt lgkmcnt(4)
    v_mfma_f32_32x32x16_bf16 v[112:127], v[56:59], v[92:95], v[112:127]
    s_waitcnt lgkmcnt(3)
    v_mfma_f32_32x32x16_bf16 v[112:127], v[60:63], v[96:99], v[112:127]
    s_waitcnt lgkmcnt(2)
    v_mfma_f32_32x32x16_bf16 v[112:127], v[64:67], v[100:103], v[112:127]
    s_waitcnt lgkmcnt(1)
    v_mfma_f32_32x32x16_bf16 v[112:127], v[68:71], v[104:107], v[112:127]
    s_waitcnt lgkmcnt(0)
    v_mfma_f32_32x32x16_bf16 v[112:127], v[72:75], v[108:111], v[112:127]
    s_lshl_b32 s23, s20, 7
    s_add_u32 s23, s23, 157760
    v_lshl_add_u32 v8, v2, 2, s23
    s_nop 8
    ds_write_b32 v8, v112
    v_lshlrev_b32 v8, 2, v2
    v_add_u32 v8, 157760, v8
    s_waitcnt lgkmcnt(0)
    v_mov_b32 v10, 155672
    v_mov_b32 v11, 1
    s_mov_b64 exec, 1
    ds_add_u32 v10, v11
    s_mov_b64 exec, -1
    v_mov_b32 v10, 155672
    s_mov_b32 s23, 0
k2_attn_kernel_lw9:
    ds_read_b32 v11, v10
    s_add_u32 s23, s23, 1
    s_waitcnt lgkmcnt(0)
    v_readfirstlane_b32 s24, v11
    s_nop 0
    s_cmp_ge_u32 s24, 8
    s_cbranch_scc1 k2_attn_kernel_lwd9
    s_nop 0
    s_cmp_lt_u32 s23, 0x800000
    s_cbranch_scc1 k2_attn_kernel_lw9
k2_attn_kernel_lwd9:
    ds_read_b32 v24, v8 offset:0
    ds_read_b32 v25, v8 offset:128
    ds_read_b32 v26, v8 offset:256
    ds_read_b32 v27, v8 offset:384
    ds_read_b32 v28, v8 offset:512
    ds_read_b32 v29, v8 offset:640
    ds_read_b32 v30, v8 offset:768
    ds_read_b32 v31, v8 offset:896
    s_mul_i32 s24, s21, 2304
    s_add_u32 s24, s24, 14745600
    s_lshl_b32 s23, s20, 7
    s_add_u32 s24, s24, s23
    s_lshl_b32 s23, s20, 6
    s_add_u32 s23, s23, 158784
    v_lshlrev_b32 v9, 1, v2
    v_add_u32 v9, s23, v9
    v_lshl_add_u32 v16, v3, 4, s23
    s_waitcnt lgkmcnt(0)
    v_add_f32 v24, v24, v26
    v_add_f32 v25, v25, v27
    v_add_f32 v28, v28, v30
    v_add_f32 v29, v29, v31
    v_add_f32 v24, v24, v28
    v_add_f32 v25, v25, v29
    v_cvt_pk_bf16_f32 v24, v24, v24
    v_lshlrev_b32 v24, 16, v24
    v_cvt_pk_bf16_f32 v25, v25, v25
    v_lshlrev_b32 v25, 16, v25
    v_mul_f32 v26, 0xbfb8aa3b, v24
    v_exp_f32 v26, v26
    s_nop 0
    v_add_f32 v26, 1.0, v26
    v_rcp_f32 v26, v26
    s_nop 0
    v_mul_f32 v26, v24, v26
    v_cvt_pk_bf16_f32 v26, v26, v26
    v_lshlrev_b32 v26, 16, v26
    v_mul_f32 v26, v26, v25
    v_cvt_pk_bf16_f32 v26, v26, v26
    ds_write_b16 v9, v26
    v_lshlrev_b32 v9, 2, v2
    s_waitcnt lgkmcnt(0)
    ds_read_b128 v[40:43], v16
    ds_read_b128 v[44:47], v16 offset:32
    s_waitcnt lgkmcnt(0)
    v_mfma_f32_32x32x16_bf16 v[48:63], v[40:43], v[128:131], 0
    v_mfma_f32_32x32x16_bf16 v[48:63], v[44:47], v[132:135], v[48:63]
    v_mfma_f32_32x32x16_bf16 v[64:79], v[40:43], v[136:139], 0
    v_mfma_f32_32x32x16_bf16 v[64:79], v[44:47], v[140:143], v[64:79]
    v_mfma_f32_32x32x16_bf16 v[80:95], v[40:43], v[144:147], 0
    v_mfma_f32_32x32x16_bf16 v[80:95], v[44:47], v[148:151], v[80:95]
    s_mov_b64 exec, 0xffffffff
    s_nop 6
    buffer_store_dword v48, v9, s[12:15], s24 offen offset:0 sc1
    s_nop 0
    buffer_store_dword v64, v9, s[12:15], s24 offen offset:1024 sc1
    s_cmp_gt_u32 s20, 1
    s_cbranch_scc1 k2_attn_kernel_ffin
    buffer_store_dword v80, v9, s[12:15], s24 offen offset:2048 sc1
k2_attn_kernel_ffin:
    s_endpgm
k2_attn_kernel_loader:
    s_sub_u32 s27, s22, 8
    s_lshl_b32 s27, s27, 10
    s_add_u32 s27, s27, 24576
    s_cmp_eq_u32 s26, 0
    s_cbranch_scc1 k2_attn_kernel_lfast
k2_attn_kernel_ldx:
    s_mov_b32 m0, s27
    s_add_u32 s24, s25, s27
    buffer_load_dwordx4 v7, s[12:15], s24 offen lds
    s_add_u32 s27, s27, 4096
    s_cmp_lt_u32 s27, 155648
    s_cbranch_scc1 k2_attn_kernel_ldx
    s_waitcnt vmcnt(0)
    s_barrier
    s_barrier
    s_barrier
    s_branch k2_attn_kernel_lend
k2_attn_kernel_lfast:
k2_attn_kernel_lda:
    s_mov_b32 m0, s27
    s_add_u32 s24, s25, s27
    buffer_load_dwordx4 v7, s[12:15], s24 offen lds
    s_add_u32 s27, s27, 4096
    s_cmp_lt_u32 s27, 40960
    s_cbranch_scc1 k2_attn_kernel_lda
    s_barrier
k2_attn_kernel_ldb:
    s_mov_b32 m0, s27
    s_add_u32 s24, s25, s27
    buffer_load_dwordx4 v7, s[12:15], s24 offen lds
    s_add_u32 s27, s27, 4096
    s_cmp_lt_u32 s27, 155648
    s_cbranch_scc1 k2_attn_kernel_ldb
    s_waitcnt vmcnt(28)
    s_barrier
    s_waitcnt vmcnt(0)
    s_barrier
    v_subrev_u32 v11, 512, v0
    s_sub_u32 s27, s22, 8
k2_attn_kernel_pfl:
    v_min_u32 v8, 323, v11
    v_lshlrev_b32 v9, 6, v8
    s_mul_i32 s23, s11, 20736
    buffer_load_dword v15, v9, s[40:43], s23 offen
    s_mul_i32 s24, s10, 663552
    s_add_u32 s23, s23, s24
    buffer_load_dword v15, v9, s[52:55], s23 offen
    v_mul_u32_u24 v9, 3641, v8
    v_lshrrev_b32 v9, 16, v9
    v_mul_u32_u24 v10, 18, v9
    v_sub_u32 v10, v8, v10
    v_mul_u32_u24 v9, 9216, v9
    v_lshl_add_u32 v9, v10, 6, v9
    s_mul_i32 s23, s11, 165888
    s_mul_i32 s24, s10, 1152
    s_add_u32 s23, s23, s24
    buffer_load_dword v15, v9, s[44:47], s23 offen
    buffer_load_dword v15, v9, s[48:51], s23 offen
    v_min_u32 v8, 143, v11
    v_lshlrev_b32 v9, 6, v8
    s_mul_i32 s23, s11, 9216
    s_mul_i32 s24, s10, 294912
    s_add_u32 s23, s23, s24
    buffer_load_dword v15, v9, s[36:39], s23 offen
    v_add_u32 v11, 256, v11
    s_add_u32 s27, s27, 4
    s_cmp_lt_u32 s27, 6
    s_cbranch_scc1 k2_attn_kernel_pfl
k2_attn_kernel_lend:
    s_mul_i32 s76, s11, 43
    s_lshr_b32 s76, s76, 8
    s_mul_i32 s73, s76, 6
    s_sub_u32 s73, s11, s73
    s_and_b32 s74, s22, 1
    s_bfe_u32 s75, s22, 0x10001
    v_add_u32 v8, 0, v1
    v_mul_u32_u24 v9, 1366, v8
    v_lshrrev_b32 v9, 14, v9
    v_mul_u32_u24 v10, 12, v9
    v_sub_u32 v10, v8, v10
    v_lshlrev_b32 v10, 4, v10
    v_mul_u32_u24 v11, 1152, v9
    v_add_u32 v16, v11, v10
    v_lshrrev_b32 v11, 1, v9
    v_mul_u32_u24 v12, 18, v11
    v_and_b32 v13, 1, v9
    v_add_u32 v12, v12, v13
    v_and_b32 v11, 1, v11
    v_xor_b32 v11, 1, v11
    v_lshl_add_u32 v12, v11, 4, v12
    v_mul_u32_u24 v12, 1152, v12
    v_add_u32 v19, v12, v10
    v_add_u32 v8, 64, v1
    v_mul_u32_u24 v9, 1366, v8
    v_lshrrev_b32 v9, 14, v9
    v_mul_u32_u24 v10, 12, v9
    v_sub_u32 v10, v8, v10
    v_lshlrev_b32 v10, 4, v10
    v_mul_u32_u24 v11, 1152, v9
    v_add_u32 v17, v11, v10
    v_lshrrev_b32 v11, 1, v9
    v_mul_u32_u24 v12, 18, v11
    v_and_b32 v13, 1, v9
    v_add_u32 v12, v12, v13
    v_and_b32 v11, 1, v11
    v_xor_b32 v11, 1, v11
    v_lshl_add_u32 v12, v11, 4, v12
    v_mul_u32_u24 v12, 1152, v12
    v_add_u32 v20, v12, v10
    v_add_u32 v8, 128, v1
    v_mul_u32_u24 v9, 1366, v8
    v_lshrrev_b32 v9, 14, v9
    v_mul_u32_u24 v10, 12, v9
    v_sub_u32 v10, v8, v10
    v_lshlrev_b32 v10, 4, v10
    v_mul_u32_u24 v11, 1152, v9
    v_add_u32 v18, v11, v10
    v_lshrrev_b32 v11, 1, v9
    v_mul_u32_u24 v12, 18, v11
    v_and_b32 v13, 1, v9
    v_add_u32 v12, v12, v13
    v_and_b32 v11, 1, v11
    v_xor_b32 v11, 1, v11
    v_lshl_add_u32 v12, v11, 4, v12
    v_mul_u32_u24 v12, 1152, v12
    v_add_u32 v21, v12, v10
    s_mul_i32 s76, s75, 18
    s_add_u32 s76, s76, s74
    s_mul_i32 s78, s73, 192
    s_lshl_b32 s23, s74, 1
    s_mul_i32 s77, s76, 18
    s_add_u32 s77, s77, s23
    s_mul_i32 s77, s77, 1152
    s_add_u32 s77, s77, s78
    s_mul_i32 s24, s76, 3072
    s_barrier
    s_cmp_lt_u32 s11, 24
    s_cbranch_scc1 k2_attn_kernel_dowo
    s_sub_u32 s72, s11, 24
    s_mul_i32 s23, s10, 18
    s_add_u32 s72, s72, s23
    s_and_b32 s24, s22, 3
    s_lshl_b32 s74, s24, 10
    v_lshrrev_b32 v8, 2, v1
    s_lshl_b32 s23, s24, 4
    v_add_u32 v8, s23, v8
    v_mul_u32_u24 v8, 9216, v8
    v_and_b32 v9, 3, v1
    v_lshl_add_u32 v23, v9, 4, v8
    s_lshl_b32 s73, s72, 6
    s_add_u32 m0, s74, 0
    s_add_u32 s23, s73, 0
    buffer_load_dwordx4 v23, s[44:47], s23 offen lds
    s_add_u32 m0, s74, 36864
    s_add_u32 s23, s73, 0
    buffer_load_dwordx4 v23, s[48:51], s23 offen lds
    s_add_u32 m0, s74, 4096
    s_add_u32 s23, s73, 589824
    buffer_load_dwordx4 v23, s[44:47], s23 offen lds
    s_add_u32 m0, s74, 40960
    s_add_u32 s23, s73, 589824
    buffer_load_dwordx4 v23, s[48:51], s23 offen lds
    s_add_u32 m0, s74, 8192
    s_add_u32 s23, s73, 1179648
    buffer_load_dwordx4 v23, s[44:47], s23 offen lds
    s_add_u32 m0, s74, 45056
    s_add_u32 s23, s73, 1179648
    buffer_load_dwordx4 v23, s[48:51], s23 offen lds
    s_add_u32 m0, s74, 12288
    s_add_u32 s23, s73, 1769472
    buffer_load_dwordx4 v23, s[44:47], s23 offen lds
    s_add_u32 m0, s74, 49152
    s_add_u32 s23, s73, 1769472
    buffer_load_dwordx4 v23, s[48:51], s23 offen lds
    s_add_u32 m0, s74, 16384
    s_add_u32 s23, s73, 2359296
    buffer_load_dwordx4 v23, s[44:47], s23 offen lds
    s_add_u32 m0, s74, 53248
    s_add_u32 s23, s73, 2359296
    buffer_load_dwordx4 v23, s[48:51], s23 offen lds
    s_add_u32 m0, s74, 20480
    s_add_u32 s23, s73, 2949120
    buffer_load_dwordx4 v23, s[44:47], s23 offen lds
    s_add_u32 m0, s74, 57344
    s_add_u32 s23, s73, 2949120
    buffer_load_dwordx4 v23, s[48:51], s23 offen lds
    s_add_u32 m0, s74, 24576
    s_add_u32 s23, s73, 3538944
    buffer_load_dwordx4 v23, s[44:47], s23 offen lds
    s_add_u32 m0, s74, 61440
    s_add_u32 s23, s73, 3538944
    buffer_load_dwordx4 v23, s[48:51], s23 offen lds
    s_add_u32 m0, s74, 28672
    s_add_u32 s23, s73, 4128768
    buffer_load_dwordx4 v23, s[44:47], s23 offen lds
    s_add_u32 m0, s74, 65536
    s_add_u32 s23, s73, 4128768
    buffer_load_dwordx4 v23, s[48:51], s23 offen lds
    s_add_u32 m0, s74, 32768
    s_add_u32 s23, s73, 4718592
    buffer_load_dwordx4 v23, s[44:47], s23 offen lds
    s_add_u32 m0, s74, 69632
    s_add_u32 s23, s73, 4718592
    buffer_load_dwordx4 v23, s[48:51], s23 offen lds
    s_waitcnt vmcnt(0)
    s_branch k2_attn_kernel_nowo
k2_attn_kernel_dowo:
    s_add_u32 m0, s24, 0
    s_nop 0
    buffer_load_dwordx4 v16, s[40:43], s77 offen lds
    s_add_u32 m0, s24, 1024
    s_nop 0
    buffer_load_dwordx4 v17, s[40:43], s77 offen lds
    s_add_u32 m0, s24, 2048
    s_nop 0
    buffer_load_dwordx4 v18, s[40:43], s77 offen lds
    s_add_u32 s77, s77, 41472
    s_add_u32 m0, s24, 6144
    s_nop 0
    buffer_load_dwordx4 v16, s[40:43], s77 offen lds
    s_add_u32 m0, s24, 7168
    s_nop 0
    buffer_load_dwordx4 v17, s[40:43], s77 offen lds
    s_add_u32 m0, s24, 8192
    s_nop 0
    buffer_load_dwordx4 v18, s[40:43], s77 offen lds
    s_add_u32 s77, s77, 41472
    s_add_u32 m0, s24, 12288
    s_nop 0
    buffer_load_dwordx4 v16, s[40:43], s77 offen lds
    s_add_u32 m0, s24, 13312
    s_nop 0
    buffer_load_dwordx4 v17, s[40:43], s77 offen lds
    s_add_u32 m0, s24, 14336
    s_nop 0
    buffer_load_dwordx4 v18, s[40:43], s77 offen lds
    s_add_u32 s77, s77, 41472
    s_add_u32 m0, s24, 18432
    s_nop 0
    buffer_load_dwordx4 v16, s[40:43], s77 offen lds
    s_add_u32 m0, s24, 19456
    s_nop 0
    buffer_load_dwordx4 v17, s[40:43], s77 offen lds
    s_add_u32 m0, s24, 20480
    s_nop 0
    buffer_load_dwordx4 v18, s[40:43], s77 offen lds
    s_add_u32 s77, s77, 41472
    s_add_u32 m0, s24, 24576
    s_nop 0
    buffer_load_dwordx4 v16, s[40:43], s77 offen lds
    s_add_u32 m0, s24, 25600
    s_nop 0
    buffer_load_dwordx4 v17, s[40:43], s77 offen lds
    s_add_u32 m0, s24, 26624
    s_nop 0
    buffer_load_dwordx4 v18, s[40:43], s77 offen lds
    s_add_u32 s77, s77, 41472
    s_add_u32 m0, s24, 30720
    s_nop 0
    buffer_load_dwordx4 v16, s[40:43], s77 offen lds
    s_add_u32 m0, s24, 31744
    s_nop 0
    buffer_load_dwordx4 v17, s[40:43], s77 offen lds
    s_add_u32 m0, s24, 32768
    s_nop 0
    buffer_load_dwordx4 v18, s[40:43], s77 offen lds
    s_add_u32 s77, s77, 41472
    s_add_u32 m0, s24, 36864
    s_nop 0
    buffer_load_dwordx4 v16, s[40:43], s77 offen lds
    s_add_u32 m0, s24, 37888
    s_nop 0
    buffer_load_dwordx4 v17, s[40:43], s77 offen lds
    s_add_u32 m0, s24, 38912
    s_nop 0
    buffer_load_dwordx4 v18, s[40:43], s77 offen lds
    s_add_u32 s77, s77, 41472
    s_mul_i32 s23, s74, 165888
    s_add_u32 s23, s23, 0
    s_add_u32 s23, s23, s78
    s_cmp_eq_u32 s75, 1
    s_cselect_b32 s77, s23, s77
    s_cselect_b64 s[32:33], -1, 0
    v_cndmask_b32 v22, v16, v19, s[32:33]
    s_add_u32 m0, s24, 43008
    s_nop 0
    buffer_load_dwordx4 v22, s[40:43], s77 offen lds
    v_cndmask_b32 v22, v17, v20, s[32:33]
    s_add_u32 m0, s24, 44032
    s_nop 0
    buffer_load_dwordx4 v22, s[40:43], s77 offen lds
    v_cndmask_b32 v22, v18, v21, s[32:33]
    s_add_u32 m0, s24, 45056
    s_nop 0
    buffer_load_dwordx4 v22, s[40:43], s77 offen lds
    s_add_u32 s77, s77, 41472
    s_mul_i32 s23, s74, 165888
    s_add_u32 s23, s23, 331776
    s_add_u32 s23, s23, s78
    s_cmp_eq_u32 s75, 1
    s_cselect_b32 s77, s23, s77
    s_cselect_b64 s[32:33], -1, 0
    v_cndmask_b32 v22, v16, v19, s[32:33]
    s_add_u32 m0, s24, 49152
    s_nop 0
    buffer_load_dwordx4 v22, s[40:43], s77 offen lds
    v_cndmask_b32 v22, v17, v20, s[32:33]
    s_add_u32 m0, s24, 50176
    s_nop 0
    buffer_load_dwordx4 v22, s[40:43], s77 offen lds
    v_cndmask_b32 v22, v18, v21, s[32:33]
    s_add_u32 m0, s24, 51200
    s_nop 0
    buffer_load_dwordx4 v22, s[40:43], s77 offen lds
    s_add_u32 s77, s77, 41472
    s_mul_i32 s76, s11, 43
    s_lshr_b32 s76, s76, 8
    s_lshl_b32 s72, s10, 2
    s_add_u32 s72, s72, s76
    s_lshl_b32 s72, s72, 2
    s_lshl_b32 s23, s75, 1
    s_add_u32 s72, s72, s23
    s_add_u32 s72, s72, s74
    s_mul_i32 s77, s72, 18432
    s_add_u32 s77, s77, s78
    s_mov_b32 s24, 110592
    s_cmp_eq_u32 s75, 1
    s_cselect_b32 s24, 155712, s24
    s_mul_i32 s23, s74, 3072
    s_add_u32 s24, s24, s23
    s_add_u32 m0, s24, 0
    s_nop 0
    buffer_load_dwordx4 v16, s[36:39], s77 offen lds
    s_add_u32 m0, s24, 1024
    s_nop 0
    buffer_load_dwordx4 v17, s[36:39], s77 offen lds
    s_add_u32 m0, s24, 2048
    s_nop 0
    buffer_load_dwordx4 v18, s[36:39], s77 offen lds
    s_waitcnt vmcnt(0)
k2_attn_kernel_nowo:
    s_barrier
    s_barrier
    s_branch k2_attn_kernel_tail
k2_attn_kernel_end:
    s_endpgm
code_end_marker:
    s_endpgm
.section .rodata,"a"
.p2align 6
.amdhsa_kernel k1_qkv_kernel
  .amdhsa_next_free_vgpr 208
  .amdhsa_next_free_sgpr 102
  .amdhsa_accum_offset 208
  .amdhsa_group_segment_fixed_size 0
  .amdhsa_kernarg_size 88
  .amdhsa_user_sgpr_count 2
  .amdhsa_user_sgpr_kernarg_segment_ptr 1
  .amdhsa_system_sgpr_workgroup_id_x 1
  .amdhsa_float_denorm_mode_32 3
.end_amdhsa_kernel
.p2align 6
.amdhsa_kernel k2_attn_kernel
  .amdhsa_next_free_vgpr 168
  .amdhsa_next_free_sgpr 100
  .amdhsa_accum_offset 168
  .amdhsa_group_segment_fixed_size 0
  .amdhsa_kernarg_size 88
  .amdhsa_user_sgpr_count 2
  .amdhsa_user_sgpr_kernarg_segment_ptr 1
  .amdhsa_system_sgpr_workgroup_id_x 1
  .amdhsa_float_denorm_mode_32 3
.end_amdhsa_kernel
```
